```python
import torch

def _softmax(x, axis=-1):
    return torch.softmax(x, dim=axis)
def _gelu(x):
    return torch.nn.functional.gelu(x, approximate="tanh")
def _silu(x):
    return torch.nn.functional.silu(x)
def _sigmoid(x):
    return torch.sigmoid(x)
def _layernorm(x, axis=-1, eps=1e-5):
    m = x.mean(dim=axis, keepdim=True)
    v = x.var(dim=axis, keepdim=True, unbiased=False)
    return (x - m) / torch.sqrt(v + eps)
def _scatter_add(tgt, idx, src, axis=0):
    return tgt.clone().index_add_(axis, idx, src)
def _segment_sum(src, seg, n):
    out = torch.zeros((n,) + src.shape[1:], dtype=src.dtype)
    return out.index_add_(0, seg, src)
def _pad(x, pw):
    flat = tuple(v for pair in reversed(pw) for v in pair)
    return torch.nn.functional.pad(x, flat)

kernel_name = 'parallel_sum__softmax_full_mha__dense_activation_gelu__prompt'

def setup_inputs():

    _w = (lambda a: (lambda t: t.to(torch.bfloat16) if t.is_floating_point() else t)(torch.as_tensor(a)))
    def _A_setup():
        B, S, D = 1, 2048, 512
        return {
            "x": _w((lambda *s: torch.randn(*s, dtype=torch.bfloat16) * 0.05)(B, S, D)),
            "wqkv": _w((lambda *s: torch.randn(*s, dtype=torch.bfloat16) * 0.05)(D, 3 * D)),
            "wo": _w((lambda *s: torch.randn(*s, dtype=torch.bfloat16) * 0.05)(D, D)),
        }
    _A_in = _A_setup()

    def _B_setup():
        B, S, D, F = 1, 2048, 512, 1376
        return {
            "x": _w((lambda *s: torch.randn(*s, dtype=torch.bfloat16) * 0.05)(B, S, D)),
            "w1": _w((lambda *s: torch.randn(*s, dtype=torch.bfloat16) * 0.8)(D, F) * (D ** -0.5)),
            "b1": _w((lambda *s: torch.randn(*s, dtype=torch.bfloat16) * 12.8)(F) * 0.01),
            "w2": _w((lambda *s: torch.randn(*s, dtype=torch.bfloat16) * 0.8)(F, D) * (F ** -0.5)),
            "b2": _w((lambda *s: torch.randn(*s, dtype=torch.bfloat16) * 12.8)(D) * 0.01),
        }
    _B_in = _B_setup()

    return {
        "A_x": _A_in["x"],
        "A_wqkv": _A_in["wqkv"],
        "A_wo": _A_in["wo"],
        "B_x": _B_in["x"],
        "B_w1": _B_in["w1"],
        "B_b1": _B_in["b1"],
        "B_w2": _B_in["w2"],
        "B_b2": _B_in["b2"],
    }

def reference(A_x, A_wqkv, A_wo, B_x, B_w1, B_b1, B_w2, B_b2):
    def _A_ref(x, wqkv, wo):
        B, S, D = x.shape
        H = 32; Dh = D // H
        qkv = (lambda x, *d: x.permute(*d))((x @ wqkv).reshape(B, S, 3, H, Dh), 2, 0, 3, 1, 4)
        q, k, v = qkv[0], qkv[1], qkv[2]
        scale = Dh ** -0.5
        scores = torch.einsum("bhqd,bhkd->bhqk", q, k) * scale
        p = _softmax(scores, axis=-1)
        o = torch.einsum("bhqk,bhkd->bhqd", p, v)
        return (lambda x, *d: x.permute(*d))(o, 0, 2, 1, 3).reshape(B, S, D) @ wo

    def _B_ref(x, w1, b1, w2, b2):
        h = torch.einsum("bsd,df->bsf", x, w1) + b1
        h = _gelu(h)
        return torch.einsum("bsf,fd->bsd", h, w2) + b2

    x = A_x
    xn = _layernorm(x, axis=-1)
    return x + _A_ref(xn, A_wqkv, A_wo) + _B_ref(xn, B_w1, B_b1, B_w2, B_b2)
```

```asm
; @launch grid=(256,1,1) block=(768,1,1) lds=163840
.amdgcn_target "amdgcn-amd-amdhsa--gfx950"
.text
.globl parallel_sum__softmax_full_mha__dense_activation_gelu__prompt_kernel
.p2align 8
.type parallel_sum__softmax_full_mha__dense_activation_gelu__prompt_kernel,@function
parallel_sum__softmax_full_mha__dense_activation_gelu__prompt_kernel:
    s_cmp_ge_u32 s2, 256
    s_cbranch_scc1 END_1
    s_load_dwordx4 s[4:7], s[0:1], 0
    s_load_dwordx2 s[8:9], s[0:1], 16
    s_load_dwordx8 s[12:19], s[0:1], 32
    s_load_dwordx4 s[20:23], s[0:1], 64
    s_load_dwordx2 s[36:37], s[0:1], 80
    v_lshrrev_b32 v1, 6, v0
    v_and_b32 v2, 63, v0
    v_readfirstlane_b32 s24, v1
    s_and_b32 s29, s2, 7
    s_lshr_b32 s30, s2, 3
    s_and_b32 s25, s29, 3
    s_lshl_b32 s25, s25, 3
    s_and_b32 s31, s30, 7
    s_add_u32 s25, s25, s31
    s_and_b32 s26, s29, 4
    s_lshr_b32 s31, s30, 3
    s_add_u32 s26, s26, s31
    s_lshl_b32 s27, s29, 2
    s_and_b32 s31, s30, 3
    s_add_u32 s27, s27, s31
    s_lshr_b32 s28, s30, 2
    s_mov_b32 s38, 14221568
    s_mov_b32 s39, 0x00020000
    s_getpc_b64 s[10:11]
    s_mul_i32 s31, s30, 12
    s_add_u32 s31, s31, s24
    s_mul_i32 s32, s31, 410
    s_lshr_b32 s32, s32, 16
    s_mul_i32 s32, s32, 160
    s_sub_u32 s31, s31, s32
    s_lshl_b32 s31, s31, 7
    v_mov_b32 v1, s31
    s_mov_b64 exec, 1
    global_load_dword v1, v1, s[10:11]
    s_mov_b64 exec, -1
    s_cmp_ge_u32 s24, 8
    s_cbranch_scc1 AUX_2
    v_lshrrev_b32 v3, 3, v2
    v_and_b32 v4, 7, v2
    s_lshl_b32 s29, s25, 6
    s_lshl_b32 s30, s24, 3
    s_add_u32 s29, s29, s30
    s_lshl_b32 s29, s29, 10
    v_lshlrev_b32 v5, 10, v3
    v_lshl_add_u32 v5, v4, 4, v5
    s_and_b32 s56, s24, 1
    s_lshr_b32 s57, s24, 1
    s_and_b32 s57, s57, 1
    s_lshr_b32 s58, s24, 2
    s_mov_b32 s42, 2097152
    s_mov_b32 s43, 0x00020000
    s_mov_b32 s46, 2752
    s_mov_b32 s47, 0x00020000
    s_waitcnt lgkmcnt(0)
    s_mov_b32 s40, s4
    s_mov_b32 s41, s5
    s_mov_b32 s44, s14
    s_mov_b32 s45, s15
    buffer_load_dwordx4 v[84:87], v5, s[40:43], s29 offen offset:0
    buffer_load_dwordx4 v[88:91], v5, s[40:43], s29 offen offset:128
    buffer_load_dwordx4 v[92:95], v5, s[40:43], s29 offen offset:256
    buffer_load_dwordx4 v[96:99], v5, s[40:43], s29 offen offset:384
    buffer_load_dwordx4 v[100:103], v5, s[40:43], s29 offen offset:512
    buffer_load_dwordx4 v[104:107], v5, s[40:43], s29 offen offset:640
    buffer_load_dwordx4 v[108:111], v5, s[40:43], s29 offen offset:768
    buffer_load_dwordx4 v[112:115], v5, s[40:43], s29 offen offset:896
    s_mul_i32 s30, s26, 192
    s_lshl_b32 s31, s58, 7
    s_add_u32 s30, s30, s31
    s_lshl_b32 s31, s57, 5
    s_add_u32 s59, s30, s31
    v_and_b32 v6, 31, v2
    v_and_b32 v7, 32, v2
    v_lshl_add_u32 v7, v7, 16, v6
    v_add_u32 v7, s59, v7
    v_lshlrev_b32 v7, 1, v7
    buffer_load_ushort v12, v7, s[44:47], 0 offen
    buffer_load_ushort v16, v7, s[44:47], 0 offen offset:128
    s_barrier
    v_lshrrev_b32 v7, 5, v2
    v_and_b32 v8, 15, v2
    v_xor_b32 v9, v8, v7
    s_lshl_b32 s30, s56, 15
    v_lshl_add_u32 v10, v6, 10, s30
    v_lshl_add_u32 v24, v9, 4, v10
    v_xor_b32 v25, 32, v24
    v_xor_b32 v26, 64, v24
    v_xor_b32 v27, 96, v24
    s_and_b32 s65, s25, 7
    s_lshl_b32 s65, s65, 7
    v_lshrrev_b32 v8, 2, v8
    v_lshl_add_u32 v8, v7, 3, v8
    v_lshlrev_b32 v8, 7, v8
    v_and_b32 v9, 1, v3
    v_xor_b32 v9, s57, v9
    v_lshl_add_u32 v8, v9, 6, v8
    v_bfe_u32 v9, v2, 4, 1
    v_lshl_add_u32 v8, v9, 5, v8
    v_and_b32 v9, 3, v2
    v_lshl_add_u32 v8, v9, 3, v8
    s_lshl_b32 s30, s58, 14
    s_add_u32 s30, s30, 65536
    v_add_u32 v32, s30, v8
    v_add_u32 v33, 49152, v32
    v_mov_b32 v20, 0x3f80
    v_mov_b32 v13, 0
    v_mov_b32 v14, 0
    v_mov_b32 v15, 0
    v_mov_b32 v17, 0
    v_mov_b32 v18, 0
    v_mov_b32 v19, 0
    v_mov_b32 v21, 0
    v_mov_b32 v22, 0
    v_mov_b32 v23, 0
    s_lshl_b32 s30, s24, 3
    v_add_u32 v9, s30, v3
    v_and_b32 v10, 15, v9
    v_xor_b32 v10, v10, v4
    v_lshlrev_b32 v10, 4, v10
    v_lshl_add_u32 v6, v9, 10, v10
    v_xor_b32 v7, 128, v6
    v_mov_b32 v8, 0x3f803f80
    v_mov_b32 v36, 0
    v_mov_b32 v37, 0
    v_mov_b32 v38, 0
    v_mov_b32 v39, 0
    s_waitcnt vmcnt(9)
    v_dot2_f32_bf16 v36, v84, v8, v36
    v_dot2_f32_bf16 v38, v84, v84, v38
    v_dot2_f32_bf16 v37, v85, v8, v37
    v_dot2_f32_bf16 v39, v85, v85, v39
    v_dot2_f32_bf16 v36, v86, v8, v36
    v_dot2_f32_bf16 v38, v86, v86, v38
    v_dot2_f32_bf16 v37, v87, v8, v37
    v_dot2_f32_bf16 v39, v87, v87, v39
    s_waitcnt vmcnt(8)
    v_dot2_f32_bf16 v36, v88, v8, v36
    v_dot2_f32_bf16 v38, v88, v88, v38
    v_dot2_f32_bf16 v37, v89, v8, v37
    v_dot2_f32_bf16 v39, v89, v89, v39
    v_dot2_f32_bf16 v36, v90, v8, v36
    v_dot2_f32_bf16 v38, v90, v90, v38
    v_dot2_f32_bf16 v37, v91, v8, v37
    v_dot2_f32_bf16 v39, v91, v91, v39
    s_waitcnt vmcnt(7)
    v_dot2_f32_bf16 v36, v92, v8, v36
    v_dot2_f32_bf16 v38, v92, v92, v38
    v_dot2_f32_bf16 v37, v93, v8, v37
    v_dot2_f32_bf16 v39, v93, v93, v39
    v_dot2_f32_bf16 v36, v94, v8, v36
    v_dot2_f32_bf16 v38, v94, v94, v38
    v_dot2_f32_bf16 v37, v95, v8, v37
    v_dot2_f32_bf16 v39, v95, v95, v39
    s_waitcnt vmcnt(6)
    v_dot2_f32_bf16 v36, v96, v8, v36
    v_dot2_f32_bf16 v38, v96, v96, v38
    v_dot2_f32_bf16 v37, v97, v8, v37
    v_dot2_f32_bf16 v39, v97, v97, v39
    v_dot2_f32_bf16 v36, v98, v8, v36
    v_dot2_f32_bf16 v38, v98, v98, v38
    v_dot2_f32_bf16 v37, v99, v8, v37
    v_dot2_f32_bf16 v39, v99, v99, v39
    s_waitcnt vmcnt(5)
    v_dot2_f32_bf16 v36, v100, v8, v36
    v_dot2_f32_bf16 v38, v100, v100, v38
    v_dot2_f32_bf16 v37, v101, v8, v37
    v_dot2_f32_bf16 v39, v101, v101, v39
    v_dot2_f32_bf16 v36, v102, v8, v36
    v_dot2_f32_bf16 v38, v102, v102, v38
    v_dot2_f32_bf16 v37, v103, v8, v37
    v_dot2_f32_bf16 v39, v103, v103, v39
    s_waitcnt vmcnt(4)
    v_dot2_f32_bf16 v36, v104, v8, v36
    v_dot2_f32_bf16 v38, v104, v104, v38
    v_dot2_f32_bf16 v37, v105, v8, v37
    v_dot2_f32_bf16 v39, v105, v105, v39
    v_dot2_f32_bf16 v36, v106, v8, v36
    v_dot2_f32_bf16 v38, v106, v106, v38
    v_dot2_f32_bf16 v37, v107, v8, v37
    v_dot2_f32_bf16 v39, v107, v107, v39
    s_waitcnt vmcnt(3)
    v_dot2_f32_bf16 v36, v108, v8, v36
    v_dot2_f32_bf16 v38, v108, v108, v38
    v_dot2_f32_bf16 v37, v109, v8, v37
    v_dot2_f32_bf16 v39, v109, v109, v39
    v_dot2_f32_bf16 v36, v110, v8, v36
    v_dot2_f32_bf16 v38, v110, v110, v38
    v_dot2_f32_bf16 v37, v111, v8, v37
    v_dot2_f32_bf16 v39, v111, v111, v39
    s_waitcnt vmcnt(2)
    v_dot2_f32_bf16 v36, v112, v8, v36
    v_dot2_f32_bf16 v38, v112, v112, v38
    v_dot2_f32_bf16 v37, v113, v8, v37
    v_dot2_f32_bf16 v39, v113, v113, v39
    v_dot2_f32_bf16 v36, v114, v8, v36
    v_dot2_f32_bf16 v38, v114, v114, v38
    v_dot2_f32_bf16 v37, v115, v8, v37
    v_dot2_f32_bf16 v39, v115, v115, v39
    s_nop 2
    v_add_f32 v36, v36, v37
    v_add_f32 v38, v38, v39
    s_nop 1
    v_add_f32_dpp v36, v36, v36 quad_perm:[1,0,3,2] row_mask:0xf bank_mask:0xf
    v_add_f32_dpp v38, v38, v38 quad_perm:[1,0,3,2] row_mask:0xf bank_mask:0xf
    s_nop 1
    v_add_f32_dpp v36, v36, v36 quad_perm:[2,3,0,1] row_mask:0xf bank_mask:0xf
    v_add_f32_dpp v38, v38, v38 quad_perm:[2,3,0,1] row_mask:0xf bank_mask:0xf
    s_nop 1
    v_add_f32_dpp v36, v36, v36 row_half_mirror row_mask:0xf bank_mask:0xf
    v_add_f32_dpp v38, v38, v38 row_half_mirror row_mask:0xf bank_mask:0xf
    v_mul_f32 v36, 0x3b000000, v36
    v_mul_f32 v38, 0x3b000000, v38
    v_fma_f32 v38, -v36, v36, v38
    v_max_f32 v38, 0, v38
    v_cvt_pk_bf16_f32 v36, -v36, v38
    v_and_b32 v38, 0xffff0000, v36
    v_add_f32 v38, 0x3727c5ac, v38
    v_cvt_pk_bf16_f32 v38, v38, v38
    v_and_b32 v38, 0xffff0000, v38
    v_sqrt_f32 v38, v38
    v_lshlrev_b32 v36, 16, v36
    v_cvt_pk_bf16_f32 v38, v38, v38
    v_and_b32 v38, 0xffff0000, v38
    v_rcp_f32 v40, v38
    s_nop 0
    v_mul_f32 v41, v36, v40
    v_lshlrev_b32 v48, 16, v84
    v_and_b32 v49, 0xffff0000, v84
    v_lshlrev_b32 v50, 16, v85
    v_and_b32 v51, 0xffff0000, v85
    v_lshlrev_b32 v52, 16, v86
    v_and_b32 v53, 0xffff0000, v86
    v_lshlrev_b32 v54, 16, v87
    v_and_b32 v55, 0xffff0000, v87
    v_pk_fma_f32 v[48:49], v[48:49], v[40:41], v[40:41] op_sel:[0,0,1] op_sel_hi:[1,0,1]
    v_pk_fma_f32 v[50:51], v[50:51], v[40:41], v[40:41] op_sel:[0,0,1] op_sel_hi:[1,0,1]
    v_pk_fma_f32 v[52:53], v[52:53], v[40:41], v[40:41] op_sel:[0,0,1] op_sel_hi:[1,0,1]
    v_pk_fma_f32 v[54:55], v[54:55], v[40:41], v[40:41] op_sel:[0,0,1] op_sel_hi:[1,0,1]
    v_cvt_pk_bf16_f32 v84, v48, v49
    v_cvt_pk_bf16_f32 v85, v50, v51
    v_cvt_pk_bf16_f32 v86, v52, v53
    v_cvt_pk_bf16_f32 v87, v54, v55
    ds_write_b128 v6, v[84:87] offset:0
    v_lshlrev_b32 v48, 16, v88
    v_and_b32 v49, 0xffff0000, v88
    v_lshlrev_b32 v50, 16, v89
    v_and_b32 v51, 0xffff0000, v89
    v_lshlrev_b32 v52, 16, v90
    v_and_b32 v53, 0xffff0000, v90
    v_lshlrev_b32 v54, 16, v91
    v_and_b32 v55, 0xffff0000, v91
    v_pk_fma_f32 v[48:49], v[48:49], v[40:41], v[40:41] op_sel:[0,0,1] op_sel_hi:[1,0,1]
    v_pk_fma_f32 v[50:51], v[50:51], v[40:41], v[40:41] op_sel:[0,0,1] op_sel_hi:[1,0,1]
    v_pk_fma_f32 v[52:53], v[52:53], v[40:41], v[40:41] op_sel:[0,0,1] op_sel_hi:[1,0,1]
    v_pk_fma_f32 v[54:55], v[54:55], v[40:41], v[40:41] op_sel:[0,0,1] op_sel_hi:[1,0,1]
    v_cvt_pk_bf16_f32 v88, v48, v49
    v_cvt_pk_bf16_f32 v89, v50, v51
    v_cvt_pk_bf16_f32 v90, v52, v53
    v_cvt_pk_bf16_f32 v91, v54, v55
    ds_write_b128 v7, v[88:91] offset:0
    v_lshlrev_b32 v48, 16, v92
    v_and_b32 v49, 0xffff0000, v92
    v_lshlrev_b32 v50, 16, v93
    v_and_b32 v51, 0xffff0000, v93
    v_lshlrev_b32 v52, 16, v94
    v_and_b32 v53, 0xffff0000, v94
    v_lshlrev_b32 v54, 16, v95
    v_and_b32 v55, 0xffff0000, v95
    v_pk_fma_f32 v[48:49], v[48:49], v[40:41], v[40:41] op_sel:[0,0,1] op_sel_hi:[1,0,1]
    v_pk_fma_f32 v[50:51], v[50:51], v[40:41], v[40:41] op_sel:[0,0,1] op_sel_hi:[1,0,1]
    v_pk_fma_f32 v[52:53], v[52:53], v[40:41], v[40:41] op_sel:[0,0,1] op_sel_hi:[1,0,1]
    v_pk_fma_f32 v[54:55], v[54:55], v[40:41], v[40:41] op_sel:[0,0,1] op_sel_hi:[1,0,1]
    v_cvt_pk_bf16_f32 v92, v48, v49
    v_cvt_pk_bf16_f32 v93, v50, v51
    v_cvt_pk_bf16_f32 v94, v52, v53
    v_cvt_pk_bf16_f32 v95, v54, v55
    ds_write_b128 v6, v[92:95] offset:256
    v_lshlrev_b32 v48, 16, v96
    v_and_b32 v49, 0xffff0000, v96
    v_lshlrev_b32 v50, 16, v97
    v_and_b32 v51, 0xffff0000, v97
    v_lshlrev_b32 v52, 16, v98
    v_and_b32 v53, 0xffff0000, v98
    v_lshlrev_b32 v54, 16, v99
    v_and_b32 v55, 0xffff0000, v99
    v_pk_fma_f32 v[48:49], v[48:49], v[40:41], v[40:41] op_sel:[0,0,1] op_sel_hi:[1,0,1]
    v_pk_fma_f32 v[50:51], v[50:51], v[40:41], v[40:41] op_sel:[0,0,1] op_sel_hi:[1,0,1]
    v_pk_fma_f32 v[52:53], v[52:53], v[40:41], v[40:41] op_sel:[0,0,1] op_sel_hi:[1,0,1]
    v_pk_fma_f32 v[54:55], v[54:55], v[40:41], v[40:41] op_sel:[0,0,1] op_sel_hi:[1,0,1]
    v_cvt_pk_bf16_f32 v96, v48, v49
    v_cvt_pk_bf16_f32 v97, v50, v51
    v_cvt_pk_bf16_f32 v98, v52, v53
    v_cvt_pk_bf16_f32 v99, v54, v55
    ds_write_b128 v7, v[96:99] offset:256
    v_lshlrev_b32 v48, 16, v100
    v_and_b32 v49, 0xffff0000, v100
    v_lshlrev_b32 v50, 16, v101
    v_and_b32 v51, 0xffff0000, v101
    v_lshlrev_b32 v52, 16, v102
    v_and_b32 v53, 0xffff0000, v102
    v_lshlrev_b32 v54, 16, v103
    v_and_b32 v55, 0xffff0000, v103
    v_pk_fma_f32 v[48:49], v[48:49], v[40:41], v[40:41] op_sel:[0,0,1] op_sel_hi:[1,0,1]
    v_pk_fma_f32 v[50:51], v[50:51], v[40:41], v[40:41] op_sel:[0,0,1] op_sel_hi:[1,0,1]
    v_pk_fma_f32 v[52:53], v[52:53], v[40:41], v[40:41] op_sel:[0,0,1] op_sel_hi:[1,0,1]
    v_pk_fma_f32 v[54:55], v[54:55], v[40:41], v[40:41] op_sel:[0,0,1] op_sel_hi:[1,0,1]
    v_cvt_pk_bf16_f32 v100, v48, v49
    v_cvt_pk_bf16_f32 v101, v50, v51
    v_cvt_pk_bf16_f32 v102, v52, v53
    v_cvt_pk_bf16_f32 v103, v54, v55
    ds_write_b128 v6, v[100:103] offset:512
    v_lshlrev_b32 v48, 16, v104
    v_and_b32 v49, 0xffff0000, v104
    v_lshlrev_b32 v50, 16, v105
    v_and_b32 v51, 0xffff0000, v105
    v_lshlrev_b32 v52, 16, v106
    v_and_b32 v53, 0xffff0000, v106
    v_lshlrev_b32 v54, 16, v107
    v_and_b32 v55, 0xffff0000, v107
    v_pk_fma_f32 v[48:49], v[48:49], v[40:41], v[40:41] op_sel:[0,0,1] op_sel_hi:[1,0,1]
    v_pk_fma_f32 v[50:51], v[50:51], v[40:41], v[40:41] op_sel:[0,0,1] op_sel_hi:[1,0,1]
    v_pk_fma_f32 v[52:53], v[52:53], v[40:41], v[40:41] op_sel:[0,0,1] op_sel_hi:[1,0,1]
    v_pk_fma_f32 v[54:55], v[54:55], v[40:41], v[40:41] op_sel:[0,0,1] op_sel_hi:[1,0,1]
    v_cvt_pk_bf16_f32 v104, v48, v49
    v_cvt_pk_bf16_f32 v105, v50, v51
    v_cvt_pk_bf16_f32 v106, v52, v53
    v_cvt_pk_bf16_f32 v107, v54, v55
    ds_write_b128 v7, v[104:107] offset:512
    v_lshlrev_b32 v48, 16, v108
    v_and_b32 v49, 0xffff0000, v108
    v_lshlrev_b32 v50, 16, v109
    v_and_b32 v51, 0xffff0000, v109
    v_lshlrev_b32 v52, 16, v110
    v_and_b32 v53, 0xffff0000, v110
    v_lshlrev_b32 v54, 16, v111
    v_and_b32 v55, 0xffff0000, v111
    v_pk_fma_f32 v[48:49], v[48:49], v[40:41], v[40:41] op_sel:[0,0,1] op_sel_hi:[1,0,1]
    v_pk_fma_f32 v[50:51], v[50:51], v[40:41], v[40:41] op_sel:[0,0,1] op_sel_hi:[1,0,1]
    v_pk_fma_f32 v[52:53], v[52:53], v[40:41], v[40:41] op_sel:[0,0,1] op_sel_hi:[1,0,1]
    v_pk_fma_f32 v[54:55], v[54:55], v[40:41], v[40:41] op_sel:[0,0,1] op_sel_hi:[1,0,1]
    v_cvt_pk_bf16_f32 v108, v48, v49
    v_cvt_pk_bf16_f32 v109, v50, v51
    v_cvt_pk_bf16_f32 v110, v52, v53
    v_cvt_pk_bf16_f32 v111, v54, v55
    ds_write_b128 v6, v[108:111] offset:768
    v_lshlrev_b32 v48, 16, v112
    v_and_b32 v49, 0xffff0000, v112
    v_lshlrev_b32 v50, 16, v113
    v_and_b32 v51, 0xffff0000, v113
    v_lshlrev_b32 v52, 16, v114
    v_and_b32 v53, 0xffff0000, v114
    v_lshlrev_b32 v54, 16, v115
    v_and_b32 v55, 0xffff0000, v115
    v_pk_fma_f32 v[48:49], v[48:49], v[40:41], v[40:41] op_sel:[0,0,1] op_sel_hi:[1,0,1]
    v_pk_fma_f32 v[50:51], v[50:51], v[40:41], v[40:41] op_sel:[0,0,1] op_sel_hi:[1,0,1]
    v_pk_fma_f32 v[52:53], v[52:53], v[40:41], v[40:41] op_sel:[0,0,1] op_sel_hi:[1,0,1]
    v_pk_fma_f32 v[54:55], v[54:55], v[40:41], v[40:41] op_sel:[0,0,1] op_sel_hi:[1,0,1]
    v_cvt_pk_bf16_f32 v112, v48, v49
    v_cvt_pk_bf16_f32 v113, v50, v51
    v_cvt_pk_bf16_f32 v114, v52, v53
    v_cvt_pk_bf16_f32 v115, v54, v55
    ds_write_b128 v7, v[112:115] offset:768
    s_waitcnt vmcnt(0)
    s_waitcnt lgkmcnt(0)
    s_cmp_eq_u32 s58, 1
    s_cbranch_scc1 M_HI_3
    s_barrier
    s_add_u32 s31, s65, 0
    s_and_b32 s31, s31, 0x380
    v_xor_b32 v28, s31, v24
    ds_read_b128 v[36:39], v28
    v_xor_b32 v29, s31, v25
    ds_read_b128 v[48:51], v29
    ds_read_b64_tr_b16 v[40:41], v32 offset:0
    ds_read_b64_tr_b16 v[42:43], v32 offset:512
    ds_read_b64_tr_b16 v[44:45], v32 offset:8192
    ds_read_b64_tr_b16 v[46:47], v32 offset:8704
    ds_read_b64_tr_b16 v[52:53], v32 offset:2048
    ds_read_b64_tr_b16 v[54:55], v32 offset:2560
    ds_read_b64_tr_b16 v[56:57], v32 offset:10240
    ds_read_b64_tr_b16 v[58:59], v32 offset:10752
    s_waitcnt lgkmcnt(4)
    v_mfma_f32_32x32x16_bf16 v[84:99], v[40:43], v[36:39], 0
    v_mfma_f32_32x32x16_bf16 v[100:115], v[44:47], v[36:39], 0
    v_xor_b32 v30, s31, v26
    ds_read_b128 v[60:63], v30
    ds_read_b64_tr_b16 v[64:65], v32 offset:4096
    ds_read_b64_tr_b16 v[66:67], v32 offset:4608
    ds_read_b64_tr_b16 v[68:69], v32 offset:12288
    ds_read_b64_tr_b16 v[70:71], v32 offset:12800
    s_waitcnt lgkmcnt(5)
    v_mfma_f32_32x32x16_bf16 v[84:99], v[52:55], v[48:51], v[84:99]
    v_mfma_f32_32x32x16_bf16 v[100:115], v[56:59], v[48:51], v[100:115]
    v_xor_b32 v31, s31, v27
    ds_read_b128 v[72:75], v31
    ds_read_b64_tr_b16 v[76:77], v32 offset:6144
    ds_read_b64_tr_b16 v[78:79], v32 offset:6656
    ds_read_b64_tr_b16 v[80:81], v32 offset:14336
    ds_read_b64_tr_b16 v[82:83], v32 offset:14848
    s_add_u32 s32, s65, 128
    s_and_b32 s32, s32, 0x380
    v_xor_b32 v28, s32, v24
    ds_read_b128 v[36:39], v28
    v_xor_b32 v29, s32, v25
    ds_read_b128 v[48:51], v29
    s_waitcnt lgkmcnt(7)
    v_mfma_f32_32x32x16_bf16 v[84:99], v[64:67], v[60:63], v[84:99]
    v_mfma_f32_32x32x16_bf16 v[100:115], v[68:71], v[60:63], v[100:115]
    s_waitcnt lgkmcnt(2)
    s_barrier
    ds_read_b64_tr_b16 v[40:41], v32 offset:24576
    ds_read_b64_tr_b16 v[42:43], v32 offset:25088
    ds_read_b64_tr_b16 v[44:45], v32 offset:32768
    ds_read_b64_tr_b16 v[46:47], v32 offset:33280
    ds_read_b64_tr_b16 v[52:53], v32 offset:26624
    ds_read_b64_tr_b16 v[54:55], v32 offset:27136
    ds_read_b64_tr_b16 v[56:57], v32 offset:34816
    ds_read_b64_tr_b16 v[58:59], v32 offset:35328
    v_mfma_f32_32x32x16_bf16 v[84:99], v[76:79], v[72:75], v[84:99]
    v_mfma_f32_32x32x16_bf16 v[100:115], v[80:83], v[72:75], v[100:115]
    s_waitcnt lgkmcnt(4)
    v_mfma_f32_32x32x16_bf16 v[84:99], v[40:43], v[36:39], v[84:99]
    v_mfma_f32_32x32x16_bf16 v[100:115], v[44:47], v[36:39], v[100:115]
    v_xor_b32 v30, s32, v26
    ds_read_b128 v[60:63], v30
    ds_read_b64_tr_b16 v[64:65], v32 offset:28672
    ds_read_b64_tr_b16 v[66:67], v32 offset:29184
    ds_read_b64_tr_b16 v[68:69], v32 offset:36864
    ds_read_b64_tr_b16 v[70:71], v32 offset:37376
    s_waitcnt lgkmcnt(5)
    v_mfma_f32_32x32x16_bf16 v[84:99], v[52:55], v[48:51], v[84:99]
    v_mfma_f32_32x32x16_bf16 v[100:115], v[56:59], v[48:51], v[100:115]
    v_xor_b32 v31, s32, v27
    ds_read_b128 v[72:75], v31
    ds_read_b64_tr_b16 v[76:77], v32 offset:30720
    ds_read_b64_tr_b16 v[78:79], v32 offset:31232
    ds_read_b64_tr_b16 v[80:81], v32 offset:38912
    ds_read_b64_tr_b16 v[82:83], v32 offset:39424
    s_add_u32 s31, s65, 256
    s_and_b32 s31, s31, 0x380
    v_xor_b32 v28, s31, v24
    ds_read_b128 v[36:39], v28
    v_xor_b32 v29, s31, v25
    ds_read_b128 v[48:51], v29
    s_waitcnt lgkmcnt(7)
    v_mfma_f32_32x32x16_bf16 v[84:99], v[64:67], v[60:63], v[84:99]
    v_mfma_f32_32x32x16_bf16 v[100:115], v[68:71], v[60:63], v[100:115]
    s_waitcnt lgkmcnt(2)
    s_barrier
    ds_read_b64_tr_b16 v[40:41], v33 offset:0
    ds_read_b64_tr_b16 v[42:43], v33 offset:512
    ds_read_b64_tr_b16 v[44:45], v33 offset:8192
    ds_read_b64_tr_b16 v[46:47], v33 offset:8704
    ds_read_b64_tr_b16 v[52:53], v33 offset:2048
    ds_read_b64_tr_b16 v[54:55], v33 offset:2560
    ds_read_b64_tr_b16 v[56:57], v33 offset:10240
    ds_read_b64_tr_b16 v[58:59], v33 offset:10752
    v_mfma_f32_32x32x16_bf16 v[84:99], v[76:79], v[72:75], v[84:99]
    v_mfma_f32_32x32x16_bf16 v[100:115], v[80:83], v[72:75], v[100:115]
    s_waitcnt lgkmcnt(4)
    v_mfma_f32_32x32x16_bf16 v[84:99], v[40:43], v[36:39], v[84:99]
    v_mfma_f32_32x32x16_bf16 v[100:115], v[44:47], v[36:39], v[100:115]
    v_xor_b32 v30, s31, v26
    ds_read_b128 v[60:63], v30
    ds_read_b64_tr_b16 v[64:65], v33 offset:4096
    ds_read_b64_tr_b16 v[66:67], v33 offset:4608
    ds_read_b64_tr_b16 v[68:69], v33 offset:12288
    ds_read_b64_tr_b16 v[70:71], v33 offset:12800
    s_waitcnt lgkmcnt(5)
    v_mfma_f32_32x32x16_bf16 v[84:99], v[52:55], v[48:51], v[84:99]
    v_mfma_f32_32x32x16_bf16 v[100:115], v[56:59], v[48:51], v[100:115]
    v_xor_b32 v31, s31, v27
    ds_read_b128 v[72:75], v31
    ds_read_b64_tr_b16 v[76:77], v33 offset:6144
    ds_read_b64_tr_b16 v[78:79], v33 offset:6656
    ds_read_b64_tr_b16 v[80:81], v33 offset:14336
    ds_read_b64_tr_b16 v[82:83], v33 offset:14848
    s_add_u32 s32, s65, 384
    s_and_b32 s32, s32, 0x380
    v_xor_b32 v28, s32, v24
    ds_read_b128 v[36:39], v28
    v_xor_b32 v29, s32, v25
    ds_read_b128 v[48:51], v29
    s_waitcnt lgkmcnt(7)
    v_mfma_f32_32x32x16_bf16 v[84:99], v[64:67], v[60:63], v[84:99]
    v_mfma_f32_32x32x16_bf16 v[100:115], v[68:71], v[60:63], v[100:115]
    s_waitcnt lgkmcnt(2)
    s_barrier
    ds_read_b64_tr_b16 v[40:41], v33 offset:24576
    ds_read_b64_tr_b16 v[42:43], v33 offset:25088
    ds_read_b64_tr_b16 v[44:45], v33 offset:32768
    ds_read_b64_tr_b16 v[46:47], v33 offset:33280
    ds_read_b64_tr_b16 v[52:53], v33 offset:26624
    ds_read_b64_tr_b16 v[54:55], v33 offset:27136
    ds_read_b64_tr_b16 v[56:57], v33 offset:34816
    ds_read_b64_tr_b16 v[58:59], v33 offset:35328
    v_mfma_f32_32x32x16_bf16 v[84:99], v[76:79], v[72:75], v[84:99]
    v_mfma_f32_32x32x16_bf16 v[100:115], v[80:83], v[72:75], v[100:115]
    s_waitcnt lgkmcnt(4)
    v_mfma_f32_32x32x16_bf16 v[84:99], v[40:43], v[36:39], v[84:99]
    v_mfma_f32_32x32x16_bf16 v[100:115], v[44:47], v[36:39], v[100:115]
    v_xor_b32 v30, s32, v26
    ds_read_b128 v[60:63], v30
    ds_read_b64_tr_b16 v[64:65], v33 offset:28672
    ds_read_b64_tr_b16 v[66:67], v33 offset:29184
    ds_read_b64_tr_b16 v[68:69], v33 offset:36864
    ds_read_b64_tr_b16 v[70:71], v33 offset:37376
    s_waitcnt lgkmcnt(5)
    v_mfma_f32_32x32x16_bf16 v[84:99], v[52:55], v[48:51], v[84:99]
    v_mfma_f32_32x32x16_bf16 v[100:115], v[56:59], v[48:51], v[100:115]
    v_xor_b32 v31, s32, v27
    ds_read_b128 v[72:75], v31
    ds_read_b64_tr_b16 v[76:77], v33 offset:30720
    ds_read_b64_tr_b16 v[78:79], v33 offset:31232
    ds_read_b64_tr_b16 v[80:81], v33 offset:38912
    ds_read_b64_tr_b16 v[82:83], v33 offset:39424
    s_add_u32 s31, s65, 512
    s_and_b32 s31, s31, 0x380
    v_xor_b32 v28, s31, v24
    ds_read_b128 v[36:39], v28
    v_xor_b32 v29, s31, v25
    ds_read_b128 v[48:51], v29
    s_waitcnt lgkmcnt(7)
    v_mfma_f32_32x32x16_bf16 v[84:99], v[64:67], v[60:63], v[84:99]
    v_mfma_f32_32x32x16_bf16 v[100:115], v[68:71], v[60:63], v[100:115]
    s_waitcnt lgkmcnt(2)
    s_barrier
    ds_read_b64_tr_b16 v[40:41], v32 offset:0
    ds_read_b64_tr_b16 v[42:43], v32 offset:512
    ds_read_b64_tr_b16 v[44:45], v32 offset:8192
    ds_read_b64_tr_b16 v[46:47], v32 offset:8704
    ds_read_b64_tr_b16 v[52:53], v32 offset:2048
    ds_read_b64_tr_b16 v[54:55], v32 offset:2560
    ds_read_b64_tr_b16 v[56:57], v32 offset:10240
    ds_read_b64_tr_b16 v[58:59], v32 offset:10752
    v_mfma_f32_32x32x16_bf16 v[84:99], v[76:79], v[72:75], v[84:99]
    v_mfma_f32_32x32x16_bf16 v[100:115], v[80:83], v[72:75], v[100:115]
    s_waitcnt lgkmcnt(4)
    v_mfma_f32_32x32x16_bf16 v[84:99], v[40:43], v[36:39], v[84:99]
    v_mfma_f32_32x32x16_bf16 v[100:115], v[44:47], v[36:39], v[100:115]
    v_xor_b32 v30, s31, v26
    ds_read_b128 v[60:63], v30
    ds_read_b64_tr_b16 v[64:65], v32 offset:4096
    ds_read_b64_tr_b16 v[66:67], v32 offset:4608
    ds_read_b64_tr_b16 v[68:69], v32 offset:12288
    ds_read_b64_tr_b16 v[70:71], v32 offset:12800
    s_waitcnt lgkmcnt(5)
    v_mfma_f32_32x32x16_bf16 v[84:99], v[52:55], v[48:51], v[84:99]
    v_mfma_f32_32x32x16_bf16 v[100:115], v[56:59], v[48:51], v[100:115]
    v_xor_b32 v31, s31, v27
    ds_read_b128 v[72:75], v31
    ds_read_b64_tr_b16 v[76:77], v32 offset:6144
    ds_read_b64_tr_b16 v[78:79], v32 offset:6656
    ds_read_b64_tr_b16 v[80:81], v32 offset:14336
    ds_read_b64_tr_b16 v[82:83], v32 offset:14848
    s_add_u32 s32, s65, 640
    s_and_b32 s32, s32, 0x380
    v_xor_b32 v28, s32, v24
    ds_read_b128 v[36:39], v28
    v_xor_b32 v29, s32, v25
    ds_read_b128 v[48:51], v29
    s_waitcnt lgkmcnt(7)
    v_mfma_f32_32x32x16_bf16 v[84:99], v[64:67], v[60:63], v[84:99]
    v_mfma_f32_32x32x16_bf16 v[100:115], v[68:71], v[60:63], v[100:115]
    s_waitcnt lgkmcnt(2)
    s_barrier
    ds_read_b64_tr_b16 v[40:41], v32 offset:24576
    ds_read_b64_tr_b16 v[42:43], v32 offset:25088
    ds_read_b64_tr_b16 v[44:45], v32 offset:32768
    ds_read_b64_tr_b16 v[46:47], v32 offset:33280
    ds_read_b64_tr_b16 v[52:53], v32 offset:26624
    ds_read_b64_tr_b16 v[54:55], v32 offset:27136
    ds_read_b64_tr_b16 v[56:57], v32 offset:34816
    ds_read_b64_tr_b16 v[58:59], v32 offset:35328
    v_mfma_f32_32x32x16_bf16 v[84:99], v[76:79], v[72:75], v[84:99]
    v_mfma_f32_32x32x16_bf16 v[100:115], v[80:83], v[72:75], v[100:115]
    s_waitcnt lgkmcnt(4)
    v_mfma_f32_32x32x16_bf16 v[84:99], v[40:43], v[36:39], v[84:99]
    v_mfma_f32_32x32x16_bf16 v[100:115], v[44:47], v[36:39], v[100:115]
    v_xor_b32 v30, s32, v26
    ds_read_b128 v[60:63], v30
    ds_read_b64_tr_b16 v[64:65], v32 offset:28672
    ds_read_b64_tr_b16 v[66:67], v32 offset:29184
    ds_read_b64_tr_b16 v[68:69], v32 offset:36864
    ds_read_b64_tr_b16 v[70:71], v32 offset:37376
    s_waitcnt lgkmcnt(5)
    v_mfma_f32_32x32x16_bf16 v[84:99], v[52:55], v[48:51], v[84:99]
    v_mfma_f32_32x32x16_bf16 v[100:115], v[56:59], v[48:51], v[100:115]
    v_xor_b32 v31, s32, v27
    ds_read_b128 v[72:75], v31
    ds_read_b64_tr_b16 v[76:77], v32 offset:30720
    ds_read_b64_tr_b16 v[78:79], v32 offset:31232
    ds_read_b64_tr_b16 v[80:81], v32 offset:38912
    ds_read_b64_tr_b16 v[82:83], v32 offset:39424
    s_add_u32 s31, s65, 768
    s_and_b32 s31, s31, 0x380
    v_xor_b32 v28, s31, v24
    ds_read_b128 v[36:39], v28
    v_xor_b32 v29, s31, v25
    ds_read_b128 v[48:51], v29
    s_waitcnt lgkmcnt(7)
    v_mfma_f32_32x32x16_bf16 v[84:99], v[64:67], v[60:63], v[84:99]
    v_mfma_f32_32x32x16_bf16 v[100:115], v[68:71], v[60:63], v[100:115]
    s_waitcnt lgkmcnt(2)
    s_barrier
    ds_read_b64_tr_b16 v[40:41], v33 offset:0
    ds_read_b64_tr_b16 v[42:43], v33 offset:512
    ds_read_b64_tr_b16 v[44:45], v33 offset:8192
    ds_read_b64_tr_b16 v[46:47], v33 offset:8704
    ds_read_b64_tr_b16 v[52:53], v33 offset:2048
    ds_read_b64_tr_b16 v[54:55], v33 offset:2560
    ds_read_b64_tr_b16 v[56:57], v33 offset:10240
    ds_read_b64_tr_b16 v[58:59], v33 offset:10752
    v_mfma_f32_32x32x16_bf16 v[84:99], v[76:79], v[72:75], v[84:99]
    v_mfma_f32_32x32x16_bf16 v[100:115], v[80:83], v[72:75], v[100:115]
    s_waitcnt lgkmcnt(4)
    v_mfma_f32_32x32x16_bf16 v[84:99], v[40:43], v[36:39], v[84:99]
    v_mfma_f32_32x32x16_bf16 v[100:115], v[44:47], v[36:39], v[100:115]
    v_xor_b32 v30, s31, v26
    ds_read_b128 v[60:63], v30
    ds_read_b64_tr_b16 v[64:65], v33 offset:4096
    ds_read_b64_tr_b16 v[66:67], v33 offset:4608
    ds_read_b64_tr_b16 v[68:69], v33 offset:12288
    ds_read_b64_tr_b16 v[70:71], v33 offset:12800
    s_waitcnt lgkmcnt(5)
    v_mfma_f32_32x32x16_bf16 v[84:99], v[52:55], v[48:51], v[84:99]
    v_mfma_f32_32x32x16_bf16 v[100:115], v[56:59], v[48:51], v[100:115]
    v_xor_b32 v31, s31, v27
    ds_read_b128 v[72:75], v31
    ds_read_b64_tr_b16 v[76:77], v33 offset:6144
    ds_read_b64_tr_b16 v[78:79], v33 offset:6656
    ds_read_b64_tr_b16 v[80:81], v33 offset:14336
    ds_read_b64_tr_b16 v[82:83], v33 offset:14848
    s_add_u32 s32, s65, 896
    s_and_b32 s32, s32, 0x380
    v_xor_b32 v28, s32, v24
    ds_read_b128 v[36:39], v28
    v_xor_b32 v29, s32, v25
    ds_read_b128 v[48:51], v29
    s_waitcnt lgkmcnt(7)
    v_mfma_f32_32x32x16_bf16 v[84:99], v[64:67], v[60:63], v[84:99]
    v_mfma_f32_32x32x16_bf16 v[100:115], v[68:71], v[60:63], v[100:115]
    s_waitcnt lgkmcnt(2)
    s_barrier
    ds_read_b64_tr_b16 v[40:41], v33 offset:24576
    ds_read_b64_tr_b16 v[42:43], v33 offset:25088
    ds_read_b64_tr_b16 v[44:45], v33 offset:32768
    ds_read_b64_tr_b16 v[46:47], v33 offset:33280
    ds_read_b64_tr_b16 v[52:53], v33 offset:26624
    ds_read_b64_tr_b16 v[54:55], v33 offset:27136
    ds_read_b64_tr_b16 v[56:57], v33 offset:34816
    ds_read_b64_tr_b16 v[58:59], v33 offset:35328
    v_mfma_f32_32x32x16_bf16 v[84:99], v[76:79], v[72:75], v[84:99]
    v_mfma_f32_32x32x16_bf16 v[100:115], v[80:83], v[72:75], v[100:115]
    s_lshl_b32 s60, s25, 1
    s_add_u32 s60, s60, s56
    s_lshl_b32 s61, s26, 1
    s_add_u32 s61, s61, s57
    s_lshl_b32 s61, s61, 17
    s_lshl_b32 s29, s60, 10
    s_add_u32 s61, s61, s29
    s_add_u32 s61, s61, 0
    v_lshlrev_b32 v3, 4, v2
    v_lshrrev_b32 v4, 1, v2
    v_xor_b32 v4, v4, v2
    v_and_b32 v4, 4, v4
    v_mul_u32_u24 v4, 3, v4
    v_xor_b32 v4, v4, v2
    v_lshlrev_b32 v4, 4, v4
    s_add_u32 s62, s61, 65536
    s_add_u32 s63, s61, 2097152
    s_add_u32 s64, s61, 2162688
    s_waitcnt lgkmcnt(4)
    v_mfma_f32_32x32x16_bf16 v[84:99], v[40:43], v[36:39], v[84:99]
    v_mfma_f32_32x32x16_bf16 v[100:115], v[44:47], v[36:39], v[100:115]
    v_xor_b32 v30, s32, v26
    ds_read_b128 v[60:63], v30
    ds_read_b64_tr_b16 v[64:65], v33 offset:28672
    ds_read_b64_tr_b16 v[66:67], v33 offset:29184
    ds_read_b64_tr_b16 v[68:69], v33 offset:36864
    ds_read_b64_tr_b16 v[70:71], v33 offset:37376
    s_waitcnt lgkmcnt(5)
    v_mfma_f32_32x32x16_bf16 v[84:99], v[52:55], v[48:51], v[84:99]
    v_mfma_f32_32x32x16_bf16 v[100:115], v[56:59], v[48:51], v[100:115]
    v_xor_b32 v31, s32, v27
    ds_read_b128 v[72:75], v31
    ds_read_b64_tr_b16 v[76:77], v33 offset:30720
    ds_read_b64_tr_b16 v[78:79], v33 offset:31232
    ds_read_b64_tr_b16 v[80:81], v33 offset:38912
    ds_read_b64_tr_b16 v[82:83], v33 offset:39424
    s_add_u32 s31, s65, 0
    s_and_b32 s31, s31, 0x380
    v_xor_b32 v28, s31, v24
    ds_read_b128 v[36:39], v28
    v_xor_b32 v29, s31, v25
    ds_read_b128 v[48:51], v29
    s_waitcnt lgkmcnt(7)
    v_mfma_f32_32x32x16_bf16 v[84:99], v[64:67], v[60:63], v[84:99]
    v_mfma_f32_32x32x16_bf16 v[100:115], v[68:71], v[60:63], v[100:115]
    s_waitcnt lgkmcnt(2)
    s_barrier
    s_cmp_lg_u32 s24, 0
    s_cbranch_scc1 M_notokld_5
    v_mov_b32 v166, 0
    global_load_dwordx2 v[164:165], v166, s[22:23] sc1
M_notokld_5:
    ds_read_b64_tr_b16 v[40:41], v32 offset:0
    ds_read_b64_tr_b16 v[42:43], v32 offset:512
    ds_read_b64_tr_b16 v[44:45], v32 offset:8192
    ds_read_b64_tr_b16 v[46:47], v32 offset:8704
    ds_read_b64_tr_b16 v[52:53], v32 offset:2048
    ds_read_b64_tr_b16 v[54:55], v32 offset:2560
    ds_read_b64_tr_b16 v[56:57], v32 offset:10240
    ds_read_b64_tr_b16 v[58:59], v32 offset:10752
    v_mfma_f32_32x32x16_bf16 v[84:99], v[76:79], v[72:75], v[84:99]
    v_mfma_f32_32x32x16_bf16 v[100:115], v[80:83], v[72:75], v[100:115]
    v_mfma_f32_32x32x16_bf16 v[116:131], v[12:15], v[20:23], 0
    v_mfma_f32_32x32x16_bf16 v[132:147], v[16:19], v[20:23], 0
    s_waitcnt lgkmcnt(4)
    v_mfma_f32_32x32x16_bf16 v[116:131], v[40:43], v[36:39], v[116:131]
    v_mfma_f32_32x32x16_bf16 v[132:147], v[44:47], v[36:39], v[132:147]
    v_xor_b32 v30, s31, v26
    ds_read_b128 v[60:63], v30
    ds_read_b64_tr_b16 v[64:65], v32 offset:4096
    ds_read_b64_tr_b16 v[66:67], v32 offset:4608
    ds_read_b64_tr_b16 v[68:69], v32 offset:12288
    ds_read_b64_tr_b16 v[70:71], v32 offset:12800
    s_waitcnt lgkmcnt(5)
    v_mfma_f32_32x32x16_bf16 v[116:131], v[52:55], v[48:51], v[116:131]
    v_mfma_f32_32x32x16_bf16 v[132:147], v[56:59], v[48:51], v[132:147]
    v_xor_b32 v31, s31, v27
    ds_read_b128 v[72:75], v31
    ds_read_b64_tr_b16 v[76:77], v32 offset:6144
    ds_read_b64_tr_b16 v[78:79], v32 offset:6656
    ds_read_b64_tr_b16 v[80:81], v32 offset:14336
    ds_read_b64_tr_b16 v[82:83], v32 offset:14848
    v_cvt_pk_bf16_f32 v156, v100, v101
    v_cvt_pk_bf16_f32 v157, v102, v103
    v_cvt_pk_bf16_f32 v158, v104, v105
    v_cvt_pk_bf16_f32 v159, v106, v107
    v_cvt_pk_bf16_f32 v160, v108, v109
    v_cvt_pk_bf16_f32 v161, v110, v111
    v_cvt_pk_bf16_f32 v162, v112, v113
    v_cvt_pk_bf16_f32 v163, v114, v115
    s_add_u32 s32, s65, 128
    s_and_b32 s32, s32, 0x380
    v_xor_b32 v28, s32, v24
    ds_read_b128 v[36:39], v28
    v_xor_b32 v29, s32, v25
    ds_read_b128 v[48:51], v29
    s_waitcnt lgkmcnt(7)
    v_mfma_f32_32x32x16_bf16 v[116:131], v[64:67], v[60:63], v[116:131]
    v_mfma_f32_32x32x16_bf16 v[132:147], v[68:71], v[60:63], v[132:147]
    v_mul_f32 v84, 0x3eb8aa3b, v84
    v_mul_f32 v85, 0x3eb8aa3b, v85
    v_mul_f32 v86, 0x3eb8aa3b, v86
    v_mul_f32 v87, 0x3eb8aa3b, v87
    v_mul_f32 v88, 0x3eb8aa3b, v88
    v_mul_f32 v89, 0x3eb8aa3b, v89
    v_mul_f32 v90, 0x3eb8aa3b, v90
    v_mul_f32 v91, 0x3eb8aa3b, v91
    v_mul_f32 v92, 0x3eb8aa3b, v92
    v_mul_f32 v93, 0x3eb8aa3b, v93
    v_mul_f32 v94, 0x3eb8aa3b, v94
    v_mul_f32 v95, 0x3eb8aa3b, v95
    v_mul_f32 v96, 0x3eb8aa3b, v96
    v_mul_f32 v97, 0x3eb8aa3b, v97
    v_mul_f32 v98, 0x3eb8aa3b, v98
    v_mul_f32 v99, 0x3eb8aa3b, v99
    v_cvt_pk_bf16_f32 v148, v84, v85
    v_cvt_pk_bf16_f32 v149, v86, v87
    v_cvt_pk_bf16_f32 v150, v88, v89
    v_cvt_pk_bf16_f32 v151, v90, v91
    v_cvt_pk_bf16_f32 v152, v92, v93
    v_cvt_pk_bf16_f32 v153, v94, v95
    v_cvt_pk_bf16_f32 v154, v96, v97
    v_cvt_pk_bf16_f32 v155, v98, v99
    buffer_store_dwordx4 v[156:159], v4, s[36:39], s63 offen sc1
    buffer_store_dwordx4 v[160:163], v4, s[36:39], s64 offen sc1
    s_waitcnt lgkmcnt(2)
    s_barrier
    ds_read_b64_tr_b16 v[40:41], v32 offset:24576
    ds_read_b64_tr_b16 v[42:43], v32 offset:25088
    ds_read_b64_tr_b16 v[44:45], v32 offset:32768
    ds_read_b64_tr_b16 v[46:47], v32 offset:33280
    ds_read_b64_tr_b16 v[52:53], v32 offset:26624
    ds_read_b64_tr_b16 v[54:55], v32 offset:27136
    ds_read_b64_tr_b16 v[56:57], v32 offset:34816
    ds_read_b64_tr_b16 v[58:59], v32 offset:35328
    v_mfma_f32_32x32x16_bf16 v[116:131], v[76:79], v[72:75], v[116:131]
    v_mfma_f32_32x32x16_bf16 v[132:147], v[80:83], v[72:75], v[132:147]
    s_waitcnt lgkmcnt(4)
    v_mfma_f32_32x32x16_bf16 v[116:131], v[40:43], v[36:39], v[116:131]
    v_mfma_f32_32x32x16_bf16 v[132:147], v[44:47], v[36:39], v[132:147]
    v_xor_b32 v30, s32, v26
    ds_read_b128 v[60:63], v30
    ds_read_b64_tr_b16 v[64:65], v32 offset:28672
    ds_read_b64_tr_b16 v[66:67], v32 offset:29184
    ds_read_b64_tr_b16 v[68:69], v32 offset:36864
    ds_read_b64_tr_b16 v[70:71], v32 offset:37376
    s_mov_b32 s44, s18
    s_mov_b32 s45, s19
    s_mov_b32 s46, 1024
    v_lshrrev_b32 v9, 3, v0
    s_lshl_b32 s29, s25, 6
    v_add_u32 v20, s29, v9
    v_and_b32 v10, 7, v0
    s_lshl_b32 s29, s26, 7
    v_lshl_add_u32 v23, v10, 4, s29
    v_lshl_add_u32 v20, v20, 10, v23
    v_mov_b32 v16, v23
    v_lshlrev_b32 v23, 1, v10
    s_waitcnt lgkmcnt(5)
    v_mfma_f32_32x32x16_bf16 v[116:131], v[52:55], v[48:51], v[116:131]
    v_mfma_f32_32x32x16_bf16 v[132:147], v[56:59], v[48:51], v[132:147]
    v_xor_b32 v31, s32, v27
    ds_read_b128 v[72:75], v31
    ds_read_b64_tr_b16 v[76:77], v32 offset:30720
    ds_read_b64_tr_b16 v[78:79], v32 offset:31232
    ds_read_b64_tr_b16 v[80:81], v32 offset:38912
    ds_read_b64_tr_b16 v[82:83], v32 offset:39424
    v_and_b32 v10, 15, v9
    v_xor_b32 v23, v23, v10
    v_lshlrev_b32 v23, 4, v23
    v_lshl_add_u32 v23, v9, 8, v23
    s_and_b32 s4, s24, 1
    s_lshr_b32 s5, s24, 1
    s_lshl_b32 s29, s25, 1
    s_add_u32 s29, s29, s4
    s_mul_i32 s10, s29, 120832
    s_lshl_b32 s29, s5, 13
    s_add_u32 s10, s10, s29
    s_add_u32 s10, s10, 6291456
    s_add_u32 s11, s10, 4096
    s_lshl_b32 s29, s28, 3
    s_add_u32 s29, s29, s24
    s_mul_i32 s29, s29, 120832
    s_lshl_b32 s30, s27, 10
    s_add_u32 s29, s29, s30
    s_add_u32 s3, s29, 6291456
    v_lshlrev_b32 v1, 10, v2
    v_add_u32 v1, 1020, v1
    v_lshrrev_b32 v9, 5, v2
    s_add_u32 s31, s65, 256
    s_and_b32 s31, s31, 0x380
    v_xor_b32 v28, s31, v24
    ds_read_b128 v[36:39], v28
    v_xor_b32 v29, s31, v25
    ds_read_b128 v[48:51], v29
    s_waitcnt lgkmcnt(7)
    v_mfma_f32_32x32x16_bf16 v[116:131], v[64:67], v[60:63], v[116:131]
    v_mfma_f32_32x32x16_bf16 v[132:147], v[68:71], v[60:63], v[132:147]
    buffer_store_dwordx4 v[148:151], v3, s[36:39], s61 offen sc1
    buffer_store_dwordx4 v[152:155], v3, s[36:39], s62 offen sc1
    s_waitcnt lgkmcnt(2)
    s_barrier
    ds_read_b64_tr_b16 v[40:41], v33 offset:0
    ds_read_b64_tr_b16 v[42:43], v33 offset:512
    ds_read_b64_tr_b16 v[44:45], v33 offset:8192
    ds_read_b64_tr_b16 v[46:47], v33 offset:8704
    ds_read_b64_tr_b16 v[52:53], v33 offset:2048
    ds_read_b64_tr_b16 v[54:55], v33 offset:2560
    ds_read_b64_tr_b16 v[56:57], v33 offset:10240
    ds_read_b64_tr_b16 v[58:59], v33 offset:10752
    v_mfma_f32_32x32x16_bf16 v[116:131], v[76:79], v[72:75], v[116:131]
    v_mfma_f32_32x32x16_bf16 v[132:147], v[80:83], v[72:75], v[132:147]
    s_waitcnt lgkmcnt(4)
    v_mfma_f32_32x32x16_bf16 v[116:131], v[40:43], v[36:39], v[116:131]
    v_mfma_f32_32x32x16_bf16 v[132:147], v[44:47], v[36:39], v[132:147]
    v_xor_b32 v30, s31, v26
    ds_read_b128 v[60:63], v30
    ds_read_b64_tr_b16 v[64:65], v33 offset:4096
    ds_read_b64_tr_b16 v[66:67], v33 offset:4608
    ds_read_b64_tr_b16 v[68:69], v33 offset:12288
    ds_read_b64_tr_b16 v[70:71], v33 offset:12800
    v_bfe_u32 v21, v2, 2, 2
    v_lshl_add_u32 v21, v9, 2, v21
    v_lshlrev_b32 v21, 7, v21
    v_bfe_u32 v10, v2, 3, 1
    v_lshl_add_u32 v21, v10, 6, v21
    v_bfe_u32 v10, v2, 4, 1
    v_lshl_add_u32 v21, v10, 5, v21
    s_waitcnt lgkmcnt(5)
    v_mfma_f32_32x32x16_bf16 v[116:131], v[52:55], v[48:51], v[116:131]
    v_mfma_f32_32x32x16_bf16 v[132:147], v[56:59], v[48:51], v[132:147]
    v_xor_b32 v31, s31, v27
    ds_read_b128 v[72:75], v31
    ds_read_b64_tr_b16 v[76:77], v33 offset:6144
    ds_read_b64_tr_b16 v[78:79], v33 offset:6656
    ds_read_b64_tr_b16 v[80:81], v33 offset:14336
    ds_read_b64_tr_b16 v[82:83], v33 offset:14848
    v_and_b32 v10, 3, v2
    v_lshl_add_u32 v21, v10, 3, v21
    s_and_b32 s30, s5, 1
    s_lshl_b32 s30, s30, 14
    s_add_u32 s29, s30, 131072
    s_cmp_lt_u32 s5, 2
    s_cselect_b32 s30, s29, s30
    v_add_u32 v21, s30, v21
    v_and_b32 v22, 31, v2
    s_lshl_b32 s29, s4, 5
    v_add_u32 v22, s29, v22
    v_and_b32 v10, 15, v22
    v_xor_b32 v10, v9, v10
    s_add_u32 s32, s65, 384
    s_and_b32 s32, s32, 0x380
    v_xor_b32 v28, s32, v24
    ds_read_b128 v[36:39], v28
    v_xor_b32 v29, s32, v25
    ds_read_b128 v[48:51], v29
    s_waitcnt lgkmcnt(7)
    v_mfma_f32_32x32x16_bf16 v[116:131], v[64:67], v[60:63], v[116:131]
    v_mfma_f32_32x32x16_bf16 v[132:147], v[68:71], v[60:63], v[132:147]
    s_waitcnt lgkmcnt(2)
    s_barrier
    ds_read_b64_tr_b16 v[40:41], v33 offset:24576
    ds_read_b64_tr_b16 v[42:43], v33 offset:25088
    ds_read_b64_tr_b16 v[44:45], v33 offset:32768
    ds_read_b64_tr_b16 v[46:47], v33 offset:33280
    ds_read_b64_tr_b16 v[52:53], v33 offset:26624
    ds_read_b64_tr_b16 v[54:55], v33 offset:27136
    ds_read_b64_tr_b16 v[56:57], v33 offset:34816
    ds_read_b64_tr_b16 v[58:59], v33 offset:35328
    v_mfma_f32_32x32x16_bf16 v[116:131], v[76:79], v[72:75], v[116:131]
    v_mfma_f32_32x32x16_bf16 v[132:147], v[80:83], v[72:75], v[132:147]
    s_waitcnt lgkmcnt(4)
    v_mfma_f32_32x32x16_bf16 v[116:131], v[40:43], v[36:39], v[116:131]
    v_mfma_f32_32x32x16_bf16 v[132:147], v[44:47], v[36:39], v[132:147]
    v_xor_b32 v30, s32, v26
    ds_read_b128 v[60:63], v30
    ds_read_b64_tr_b16 v[64:65], v33 offset:28672
    ds_read_b64_tr_b16 v[66:67], v33 offset:29184
    ds_read_b64_tr_b16 v[68:69], v33 offset:36864
    ds_read_b64_tr_b16 v[70:71], v33 offset:37376
    v_lshlrev_b32 v10, 4, v10
    v_lshl_add_u32 v22, v22, 8, v10
    v_add_u32 v22, s30, v22
    s_mov_b32 s48, s20
    s_mov_b32 s49, s21
    s_mov_b32 s50, 2097152
    s_mov_b32 s51, 0x00020000
    v_mov_b32 v6, 0xdddddddd
    s_mov_b32 s66, 0x0000ffff
    s_mov_b32 s67, 0x0000ffff
    v_and_b32 v10, 15, v2
    v_lshlrev_b32 v9, 8, v9
    v_lshl_add_u32 v9, v10, 4, v9
    s_waitcnt lgkmcnt(5)
    v_mfma_f32_32x32x16_bf16 v[116:131], v[52:55], v[48:51], v[116:131]
    v_mfma_f32_32x32x16_bf16 v[132:147], v[56:59], v[48:51], v[132:147]
    v_xor_b32 v31, s32, v27
    ds_read_b128 v[72:75], v31
    ds_read_b64_tr_b16 v[76:77], v33 offset:30720
    ds_read_b64_tr_b16 v[78:79], v33 offset:31232
    ds_read_b64_tr_b16 v[80:81], v33 offset:38912
    ds_read_b64_tr_b16 v[82:83], v33 offset:39424
    v_add_u32 v7, 65536, v9
    v_and_b32 v10, 27, v2
    v_cmp_eq_u32 vcc, 16, v10
    v_mov_b32 v9, 0x3f803f80
    s_lshl_b32 s29, s24, 10
    s_add_u32 s29, s29, 131072
    v_cndmask_b32 v9, 0, v9, vcc
    v_add_u32 v8, s29, v3
    v_mov_b32 v92, v9
    s_add_u32 s31, s65, 512
    s_and_b32 s31, s31, 0x380
    v_xor_b32 v28, s31, v24
    ds_read_b128 v[36:39], v28
    v_xor_b32 v29, s31, v25
    ds_read_b128 v[48:51], v29
    s_waitcnt lgkmcnt(7)
    v_mfma_f32_32x32x16_bf16 v[116:131], v[64:67], v[60:63], v[116:131]
    v_mfma_f32_32x32x16_bf16 v[132:147], v[68:71], v[60:63], v[132:147]
    s_waitcnt lgkmcnt(2)
    s_barrier
    ds_read_b64_tr_b16 v[40:41], v32 offset:0
    ds_read_b64_tr_b16 v[42:43], v32 offset:512
    ds_read_b64_tr_b16 v[44:45], v32 offset:8192
    ds_read_b64_tr_b16 v[46:47], v32 offset:8704
    ds_read_b64_tr_b16 v[52:53], v32 offset:2048
    ds_read_b64_tr_b16 v[54:55], v32 offset:2560
    ds_read_b64_tr_b16 v[56:57], v32 offset:10240
    ds_read_b64_tr_b16 v[58:59], v32 offset:10752
    v_mfma_f32_32x32x16_bf16 v[116:131], v[76:79], v[72:75], v[116:131]
    v_mfma_f32_32x32x16_bf16 v[132:147], v[80:83], v[72:75], v[132:147]
    s_waitcnt lgkmcnt(4)
    v_mfma_f32_32x32x16_bf16 v[116:131], v[40:43], v[36:39], v[116:131]
    v_mfma_f32_32x32x16_bf16 v[132:147], v[44:47], v[36:39], v[132:147]
    v_xor_b32 v30, s31, v26
    ds_read_b128 v[60:63], v30
    ds_read_b64_tr_b16 v[64:65], v32 offset:4096
    ds_read_b64_tr_b16 v[66:67], v32 offset:4608
    ds_read_b64_tr_b16 v[68:69], v32 offset:12288
    ds_read_b64_tr_b16 v[70:71], v32 offset:12800
    v_mov_b32 v96, v9
    v_mov_b32 v88, 0
    v_mov_b32 v93, v9
    v_mov_b32 v97, v9
    v_mov_b32 v89, 0
    v_mov_b32 v94, v9
    v_mov_b32 v98, v9
    s_waitcnt lgkmcnt(5)
    v_mfma_f32_32x32x16_bf16 v[116:131], v[52:55], v[48:51], v[116:131]
    v_mfma_f32_32x32x16_bf16 v[132:147], v[56:59], v[48:51], v[132:147]
    v_xor_b32 v31, s31, v27
    ds_read_b128 v[72:75], v31
    ds_read_b64_tr_b16 v[76:77], v32 offset:6144
    ds_read_b64_tr_b16 v[78:79], v32 offset:6656
    ds_read_b64_tr_b16 v[80:81], v32 offset:14336
    ds_read_b64_tr_b16 v[82:83], v32 offset:14848
    v_mov_b32 v90, 0
    v_mov_b32 v95, v9
    v_mov_b32 v99, v9
    v_mov_b32 v91, 0
    s_add_u32 s32, s65, 640
    s_and_b32 s32, s32, 0x380
    v_xor_b32 v28, s32, v24
    ds_read_b128 v[36:39], v28
    v_xor_b32 v29, s32, v25
    ds_read_b128 v[48:51], v29
    s_waitcnt lgkmcnt(7)
    v_mfma_f32_32x32x16_bf16 v[116:131], v[64:67], v[60:63], v[116:131]
    v_mfma_f32_32x32x16_bf16 v[132:147], v[68:71], v[60:63], v[132:147]
    s_waitcnt lgkmcnt(2)
    s_waitcnt vmcnt(0)
    s_barrier
    s_cmp_lg_u32 s24, 0
    s_cbranch_scc1 M_noflag_6
    s_mov_b32 s33, 0
M_tokpoll_8:
    v_cmp_eq_u32 vcc, 0, v164
    s_cbranch_vccz M_tokok_7
    s_sleep 2
    v_mov_b32 v166, 0
    global_load_dwordx2 v[164:165], v166, s[22:23] sc1
    s_add_u32 s33, s33, 1
    s_waitcnt vmcnt(0)
    s_cmp_lt_u32 s33, 0x20000
    s_cbranch_scc1 M_tokpoll_8
M_tokok_7:
    s_lshl_b32 s62, s26, 13
    s_lshl_b32 s63, s25, 3
    s_add_u32 s62, s62, s63
    s_add_u32 s62, s62, 14024704
    v_lshlrev_b32 v166, 8, v2
    s_mov_b32 exec_hi, 0
    buffer_store_dwordx2 v[164:165], v166, s[36:39], s62 offen sc1
    s_mov_b64 exec, -1
M_noflag_6:
    ds_read_b64_tr_b16 v[40:41], v32 offset:24576
    ds_read_b64_tr_b16 v[42:43], v32 offset:25088
    ds_read_b64_tr_b16 v[44:45], v32 offset:32768
    ds_read_b64_tr_b16 v[46:47], v32 offset:33280
    ds_read_b64_tr_b16 v[52:53], v32 offset:26624
    ds_read_b64_tr_b16 v[54:55], v32 offset:27136
    ds_read_b64_tr_b16 v[56:57], v32 offset:34816
    ds_read_b64_tr_b16 v[58:59], v32 offset:35328
    v_mfma_f32_32x32x16_bf16 v[116:131], v[76:79], v[72:75], v[116:131]
    v_mfma_f32_32x32x16_bf16 v[132:147], v[80:83], v[72:75], v[132:147]
    s_waitcnt lgkmcnt(4)
    v_mfma_f32_32x32x16_bf16 v[116:131], v[40:43], v[36:39], v[116:131]
    v_mfma_f32_32x32x16_bf16 v[132:147], v[44:47], v[36:39], v[132:147]
    v_xor_b32 v30, s32, v26
    ds_read_b128 v[60:63], v30
    ds_read_b64_tr_b16 v[64:65], v32 offset:28672
    ds_read_b64_tr_b16 v[66:67], v32 offset:29184
    ds_read_b64_tr_b16 v[68:69], v32 offset:36864
    ds_read_b64_tr_b16 v[70:71], v32 offset:37376
    s_waitcnt lgkmcnt(5)
    v_mfma_f32_32x32x16_bf16 v[116:131], v[52:55], v[48:51], v[116:131]
    v_mfma_f32_32x32x16_bf16 v[132:147], v[56:59], v[48:51], v[132:147]
    v_xor_b32 v31, s32, v27
    ds_read_b128 v[72:75], v31
    ds_read_b64_tr_b16 v[76:77], v32 offset:30720
    ds_read_b64_tr_b16 v[78:79], v32 offset:31232
    ds_read_b64_tr_b16 v[80:81], v32 offset:38912
    ds_read_b64_tr_b16 v[82:83], v32 offset:39424
    s_add_u32 s31, s65, 768
    s_and_b32 s31, s31, 0x380
    v_xor_b32 v28, s31, v24
    ds_read_b128 v[36:39], v28
    v_xor_b32 v29, s31, v25
    ds_read_b128 v[48:51], v29
    s_waitcnt lgkmcnt(7)
    v_mfma_f32_32x32x16_bf16 v[116:131], v[64:67], v[60:63], v[116:131]
    v_mfma_f32_32x32x16_bf16 v[132:147], v[68:71], v[60:63], v[132:147]
    s_waitcnt lgkmcnt(2)
    s_barrier
    ds_read_b64_tr_b16 v[40:41], v33 offset:0
    ds_read_b64_tr_b16 v[42:43], v33 offset:512
    ds_read_b64_tr_b16 v[44:45], v33 offset:8192
    ds_read_b64_tr_b16 v[46:47], v33 offset:8704
    ds_read_b64_tr_b16 v[52:53], v33 offset:2048
    ds_read_b64_tr_b16 v[54:55], v33 offset:2560
    ds_read_b64_tr_b16 v[56:57], v33 offset:10240
    ds_read_b64_tr_b16 v[58:59], v33 offset:10752
    v_mfma_f32_32x32x16_bf16 v[116:131], v[76:79], v[72:75], v[116:131]
    v_mfma_f32_32x32x16_bf16 v[132:147], v[80:83], v[72:75], v[132:147]
    s_waitcnt lgkmcnt(4)
    v_mfma_f32_32x32x16_bf16 v[116:131], v[40:43], v[36:39], v[116:131]
    v_mfma_f32_32x32x16_bf16 v[132:147], v[44:47], v[36:39], v[132:147]
    v_xor_b32 v30, s31, v26
    ds_read_b128 v[60:63], v30
    ds_read_b64_tr_b16 v[64:65], v33 offset:4096
    ds_read_b64_tr_b16 v[66:67], v33 offset:4608
    ds_read_b64_tr_b16 v[68:69], v33 offset:12288
    ds_read_b64_tr_b16 v[70:71], v33 offset:12800
    s_waitcnt lgkmcnt(5)
    v_mfma_f32_32x32x16_bf16 v[116:131], v[52:55], v[48:51], v[116:131]
    v_mfma_f32_32x32x16_bf16 v[132:147], v[56:59], v[48:51], v[132:147]
    v_xor_b32 v31, s31, v27
    ds_read_b128 v[72:75], v31
    ds_read_b64_tr_b16 v[76:77], v33 offset:6144
    ds_read_b64_tr_b16 v[78:79], v33 offset:6656
    ds_read_b64_tr_b16 v[80:81], v33 offset:14336
    ds_read_b64_tr_b16 v[82:83], v33 offset:14848
    s_add_u32 s32, s65, 896
    s_and_b32 s32, s32, 0x380
    v_xor_b32 v28, s32, v24
    ds_read_b128 v[36:39], v28
    v_xor_b32 v29, s32, v25
    ds_read_b128 v[48:51], v29
    s_waitcnt lgkmcnt(7)
    v_mfma_f32_32x32x16_bf16 v[116:131], v[64:67], v[60:63], v[116:131]
    v_mfma_f32_32x32x16_bf16 v[132:147], v[68:71], v[60:63], v[132:147]
    s_waitcnt lgkmcnt(2)
    s_barrier
    ds_read_b64_tr_b16 v[40:41], v33 offset:24576
    ds_read_b64_tr_b16 v[42:43], v33 offset:25088
    ds_read_b64_tr_b16 v[44:45], v33 offset:32768
    ds_read_b64_tr_b16 v[46:47], v33 offset:33280
    ds_read_b64_tr_b16 v[52:53], v33 offset:26624
    ds_read_b64_tr_b16 v[54:55], v33 offset:27136
    ds_read_b64_tr_b16 v[56:57], v33 offset:34816
    ds_read_b64_tr_b16 v[58:59], v33 offset:35328
    v_mfma_f32_32x32x16_bf16 v[116:131], v[76:79], v[72:75], v[116:131]
    v_mfma_f32_32x32x16_bf16 v[132:147], v[80:83], v[72:75], v[132:147]
    s_waitcnt lgkmcnt(4)
    v_mfma_f32_32x32x16_bf16 v[116:131], v[40:43], v[36:39], v[116:131]
    v_mfma_f32_32x32x16_bf16 v[132:147], v[44:47], v[36:39], v[132:147]
    v_xor_b32 v30, s32, v26
    ds_read_b128 v[60:63], v30
    ds_read_b64_tr_b16 v[64:65], v33 offset:28672
    ds_read_b64_tr_b16 v[66:67], v33 offset:29184
    ds_read_b64_tr_b16 v[68:69], v33 offset:36864
    ds_read_b64_tr_b16 v[70:71], v33 offset:37376
    s_waitcnt lgkmcnt(5)
    v_mfma_f32_32x32x16_bf16 v[116:131], v[52:55], v[48:51], v[116:131]
    v_mfma_f32_32x32x16_bf16 v[132:147], v[56:59], v[48:51], v[132:147]
    v_xor_b32 v31, s32, v27
    ds_read_b128 v[72:75], v31
    ds_read_b64_tr_b16 v[76:77], v33 offset:30720
    ds_read_b64_tr_b16 v[78:79], v33 offset:31232
    ds_read_b64_tr_b16 v[80:81], v33 offset:38912
    ds_read_b64_tr_b16 v[82:83], v33 offset:39424
    s_waitcnt lgkmcnt(5)
    v_mfma_f32_32x32x16_bf16 v[116:131], v[64:67], v[60:63], v[116:131]
    v_mfma_f32_32x32x16_bf16 v[132:147], v[68:71], v[60:63], v[132:147]
    s_waitcnt lgkmcnt(0)
    s_barrier
    v_mfma_f32_32x32x16_bf16 v[116:131], v[76:79], v[72:75], v[116:131]
    v_mfma_f32_32x32x16_bf16 v[132:147], v[80:83], v[72:75], v[132:147]
    v_mov_b32 v36, 0xbdd2d3e8
    v_mov_b32 v37, 0xc0135761
    s_mul_i32 s30, s56, 12288
    s_lshl_b32 s29, s57, 11
    s_add_u32 s29, s29, s30
    s_add_u32 s29, s29, 139264
    v_add_u32 v5, s29, v3
    s_nop 6
    s_add_u32 s30, s59, 0
    s_cmp_ge_u32 s30, 1376
    s_cbranch_scc1 M_skip_9
    v_pk_mul_f32 v[48:49], v[116:117], v[116:117]
    v_pk_mul_f32 v[50:51], v[118:119], v[118:119]
    v_pk_mul_f32 v[52:53], v[120:121], v[120:121]
    v_pk_mul_f32 v[54:55], v[122:123], v[122:123]
    v_pk_mul_f32 v[56:57], v[124:125], v[124:125]
    v_pk_mul_f32 v[58:59], v[126:127], v[126:127]
    v_pk_mul_f32 v[60:61], v[128:129], v[128:129]
    v_pk_mul_f32 v[62:63], v[130:131], v[130:131]
    v_pk_fma_f32 v[48:49], v[48:49], v[36:37], v[36:37] op_sel:[0,0,1] op_sel_hi:[1,0,1]
    v_pk_fma_f32 v[50:51], v[50:51], v[36:37], v[36:37] op_sel:[0,0,1] op_sel_hi:[1,0,1]
    v_pk_fma_f32 v[52:53], v[52:53], v[36:37], v[36:37] op_sel:[0,0,1] op_sel_hi:[1,0,1]
    v_pk_fma_f32 v[54:55], v[54:55], v[36:37], v[36:37] op_sel:[0,0,1] op_sel_hi:[1,0,1]
    v_pk_fma_f32 v[56:57], v[56:57], v[36:37], v[36:37] op_sel:[0,0,1] op_sel_hi:[1,0,1]
    v_pk_fma_f32 v[58:59], v[58:59], v[36:37], v[36:37] op_sel:[0,0,1] op_sel_hi:[1,0,1]
    v_pk_fma_f32 v[60:61], v[60:61], v[36:37], v[36:37] op_sel:[0,0,1] op_sel_hi:[1,0,1]
    v_pk_fma_f32 v[62:63], v[62:63], v[36:37], v[36:37] op_sel:[0,0,1] op_sel_hi:[1,0,1]
    v_pk_mul_f32 v[48:49], v[48:49], v[116:117]
    v_pk_mul_f32 v[50:51], v[50:51], v[118:119]
    v_pk_mul_f32 v[52:53], v[52:53], v[120:121]
    v_pk_mul_f32 v[54:55], v[54:55], v[122:123]
    v_pk_mul_f32 v[56:57], v[56:57], v[124:125]
    v_pk_mul_f32 v[58:59], v[58:59], v[126:127]
    v_pk_mul_f32 v[60:61], v[60:61], v[128:129]
    v_pk_mul_f32 v[62:63], v[62:63], v[130:131]
    v_exp_f32 v48, v48
    v_exp_f32 v49, v49
    v_exp_f32 v50, v50
    v_exp_f32 v51, v51
    v_exp_f32 v52, v52
    v_exp_f32 v53, v53
    v_exp_f32 v54, v54
    v_exp_f32 v55, v55
    v_exp_f32 v56, v56
    v_exp_f32 v57, v57
    v_exp_f32 v58, v58
    v_exp_f32 v59, v59
    v_exp_f32 v60, v60
    v_exp_f32 v61, v61
    v_exp_f32 v62, v62
    v_exp_f32 v63, v63
    v_pk_add_f32 v[48:49], v[48:49], 1.0 op_sel_hi:[1,0]
    v_pk_add_f32 v[50:51], v[50:51], 1.0 op_sel_hi:[1,0]
    v_pk_add_f32 v[52:53], v[52:53], 1.0 op_sel_hi:[1,0]
    v_pk_add_f32 v[54:55], v[54:55], 1.0 op_sel_hi:[1,0]
    v_pk_add_f32 v[56:57], v[56:57], 1.0 op_sel_hi:[1,0]
    v_pk_add_f32 v[58:59], v[58:59], 1.0 op_sel_hi:[1,0]
    v_pk_add_f32 v[60:61], v[60:61], 1.0 op_sel_hi:[1,0]
    v_pk_add_f32 v[62:63], v[62:63], 1.0 op_sel_hi:[1,0]
    v_rcp_f32 v48, v48
    v_rcp_f32 v49, v49
    v_rcp_f32 v50, v50
    v_rcp_f32 v51, v51
    v_rcp_f32 v52, v52
    v_rcp_f32 v53, v53
    v_rcp_f32 v54, v54
    v_rcp_f32 v55, v55
    v_rcp_f32 v56, v56
    v_rcp_f32 v57, v57
    v_rcp_f32 v58, v58
    v_rcp_f32 v59, v59
    v_rcp_f32 v60, v60
    v_rcp_f32 v61, v61
    v_rcp_f32 v62, v62
    v_rcp_f32 v63, v63
    v_pk_mul_f32 v[48:49], v[48:49], v[116:117]
    v_pk_mul_f32 v[50:51], v[50:51], v[118:119]
    v_pk_mul_f32 v[52:53], v[52:53], v[120:121]
    v_pk_mul_f32 v[54:55], v[54:55], v[122:123]
    v_pk_mul_f32 v[56:57], v[56:57], v[124:125]
    v_pk_mul_f32 v[58:59], v[58:59], v[126:127]
    v_pk_mul_f32 v[60:61], v[60:61], v[128:129]
    v_pk_mul_f32 v[62:63], v[62:63], v[130:131]
    v_cvt_pk_bf16_f32 v148, v48, v49
    v_cvt_pk_bf16_f32 v149, v50, v51
    v_cvt_pk_bf16_f32 v150, v52, v53
    v_cvt_pk_bf16_f32 v151, v54, v55
    v_cvt_pk_bf16_f32 v152, v56, v57
    v_cvt_pk_bf16_f32 v153, v58, v59
    v_cvt_pk_bf16_f32 v154, v60, v61
    v_cvt_pk_bf16_f32 v155, v62, v63
    ds_write_b128 v5, v[148:151] offset:0
    ds_write_b128 v5, v[152:155] offset:1024
M_skip_9:
    s_add_u32 s30, s59, 64
    s_cmp_ge_u32 s30, 1376
    s_cbranch_scc1 M_skip_10
    v_pk_mul_f32 v[48:49], v[132:133], v[132:133]
    v_pk_mul_f32 v[50:51], v[134:135], v[134:135]
    v_pk_mul_f32 v[52:53], v[136:137], v[136:137]
    v_pk_mul_f32 v[54:55], v[138:139], v[138:139]
    v_pk_mul_f32 v[56:57], v[140:141], v[140:141]
    v_pk_mul_f32 v[58:59], v[142:143], v[142:143]
    v_pk_mul_f32 v[60:61], v[144:145], v[144:145]
    v_pk_mul_f32 v[62:63], v[146:147], v[146:147]
    v_pk_fma_f32 v[48:49], v[48:49], v[36:37], v[36:37] op_sel:[0,0,1] op_sel_hi:[1,0,1]
    v_pk_fma_f32 v[50:51], v[50:51], v[36:37], v[36:37] op_sel:[0,0,1] op_sel_hi:[1,0,1]
    v_pk_fma_f32 v[52:53], v[52:53], v[36:37], v[36:37] op_sel:[0,0,1] op_sel_hi:[1,0,1]
    v_pk_fma_f32 v[54:55], v[54:55], v[36:37], v[36:37] op_sel:[0,0,1] op_sel_hi:[1,0,1]
    v_pk_fma_f32 v[56:57], v[56:57], v[36:37], v[36:37] op_sel:[0,0,1] op_sel_hi:[1,0,1]
    v_pk_fma_f32 v[58:59], v[58:59], v[36:37], v[36:37] op_sel:[0,0,1] op_sel_hi:[1,0,1]
    v_pk_fma_f32 v[60:61], v[60:61], v[36:37], v[36:37] op_sel:[0,0,1] op_sel_hi:[1,0,1]
    v_pk_fma_f32 v[62:63], v[62:63], v[36:37], v[36:37] op_sel:[0,0,1] op_sel_hi:[1,0,1]
    v_pk_mul_f32 v[48:49], v[48:49], v[132:133]
    v_pk_mul_f32 v[50:51], v[50:51], v[134:135]
    v_pk_mul_f32 v[52:53], v[52:53], v[136:137]
    v_pk_mul_f32 v[54:55], v[54:55], v[138:139]
    v_pk_mul_f32 v[56:57], v[56:57], v[140:141]
    v_pk_mul_f32 v[58:59], v[58:59], v[142:143]
    v_pk_mul_f32 v[60:61], v[60:61], v[144:145]
    v_pk_mul_f32 v[62:63], v[62:63], v[146:147]
    v_exp_f32 v48, v48
    v_exp_f32 v49, v49
    v_exp_f32 v50, v50
    v_exp_f32 v51, v51
    v_exp_f32 v52, v52
    v_exp_f32 v53, v53
    v_exp_f32 v54, v54
    v_exp_f32 v55, v55
    v_exp_f32 v56, v56
    v_exp_f32 v57, v57
    v_exp_f32 v58, v58
    v_exp_f32 v59, v59
    v_exp_f32 v60, v60
    v_exp_f32 v61, v61
    v_exp_f32 v62, v62
    v_exp_f32 v63, v63
    v_pk_add_f32 v[48:49], v[48:49], 1.0 op_sel_hi:[1,0]
    v_pk_add_f32 v[50:51], v[50:51], 1.0 op_sel_hi:[1,0]
    v_pk_add_f32 v[52:53], v[52:53], 1.0 op_sel_hi:[1,0]
    v_pk_add_f32 v[54:55], v[54:55], 1.0 op_sel_hi:[1,0]
    v_pk_add_f32 v[56:57], v[56:57], 1.0 op_sel_hi:[1,0]
    v_pk_add_f32 v[58:59], v[58:59], 1.0 op_sel_hi:[1,0]
    v_pk_add_f32 v[60:61], v[60:61], 1.0 op_sel_hi:[1,0]
    v_pk_add_f32 v[62:63], v[62:63], 1.0 op_sel_hi:[1,0]
    v_rcp_f32 v48, v48
    v_rcp_f32 v49, v49
    v_rcp_f32 v50, v50
    v_rcp_f32 v51, v51
    v_rcp_f32 v52, v52
    v_rcp_f32 v53, v53
    v_rcp_f32 v54, v54
    v_rcp_f32 v55, v55
    v_rcp_f32 v56, v56
    v_rcp_f32 v57, v57
    v_rcp_f32 v58, v58
    v_rcp_f32 v59, v59
    v_rcp_f32 v60, v60
    v_rcp_f32 v61, v61
    v_rcp_f32 v62, v62
    v_rcp_f32 v63, v63
    v_pk_mul_f32 v[48:49], v[48:49], v[132:133]
    v_pk_mul_f32 v[50:51], v[50:51], v[134:135]
    v_pk_mul_f32 v[52:53], v[52:53], v[136:137]
    v_pk_mul_f32 v[54:55], v[54:55], v[138:139]
    v_pk_mul_f32 v[56:57], v[56:57], v[140:141]
    v_pk_mul_f32 v[58:59], v[58:59], v[142:143]
    v_pk_mul_f32 v[60:61], v[60:61], v[144:145]
    v_pk_mul_f32 v[62:63], v[62:63], v[146:147]
    v_cvt_pk_bf16_f32 v156, v48, v49
    v_cvt_pk_bf16_f32 v157, v50, v51
    v_cvt_pk_bf16_f32 v158, v52, v53
    v_cvt_pk_bf16_f32 v159, v54, v55
    v_cvt_pk_bf16_f32 v160, v56, v57
    v_cvt_pk_bf16_f32 v161, v58, v59
    v_cvt_pk_bf16_f32 v162, v60, v61
    v_cvt_pk_bf16_f32 v163, v62, v63
    ds_write_b128 v5, v[156:159] offset:4096
    ds_write_b128 v5, v[160:163] offset:5120
M_skip_10:
    s_branch M_JOIN_4
M_HI_3:
    s_barrier
    s_add_u32 s31, s65, 0
    s_and_b32 s31, s31, 0x380
    v_xor_b32 v28, s31, v24
    ds_read_b128 v[36:39], v28
    v_xor_b32 v29, s31, v25
    ds_read_b128 v[48:51], v29
    ds_read_b64_tr_b16 v[40:41], v32 offset:0
    ds_read_b64_tr_b16 v[42:43], v32 offset:512
    ds_read_b64_tr_b16 v[52:53], v32 offset:2048
    ds_read_b64_tr_b16 v[54:55], v32 offset:2560
    s_waitcnt lgkmcnt(2)
    v_mfma_f32_32x32x16_bf16 v[84:99], v[36:39], v[40:43], 0
    v_xor_b32 v30, s31, v26
    ds_read_b128 v[60:63], v30
    ds_read_b64_tr_b16 v[64:65], v32 offset:4096
    ds_read_b64_tr_b16 v[66:67], v32 offset:4608
    s_waitcnt lgkmcnt(3)
    v_mfma_f32_32x32x16_bf16 v[84:99], v[48:51], v[52:55], v[84:99]
    v_xor_b32 v31, s31, v27
    ds_read_b128 v[72:75], v31
    ds_read_b64_tr_b16 v[76:77], v32 offset:6144
    ds_read_b64_tr_b16 v[78:79], v32 offset:6656
    s_add_u32 s32, s65, 128
    s_and_b32 s32, s32, 0x380
    v_xor_b32 v28, s32, v24
    ds_read_b128 v[36:39], v28
    v_xor_b32 v29, s32, v25
    ds_read_b128 v[48:51], v29
    s_waitcnt lgkmcnt(5)
    v_mfma_f32_32x32x16_bf16 v[84:99], v[60:63], v[64:67], v[84:99]
    s_waitcnt lgkmcnt(2)
    s_barrier
    ds_read_b64_tr_b16 v[40:41], v32 offset:24576
    ds_read_b64_tr_b16 v[42:43], v32 offset:25088
    ds_read_b64_tr_b16 v[52:53], v32 offset:26624
    ds_read_b64_tr_b16 v[54:55], v32 offset:27136
    v_mfma_f32_32x32x16_bf16 v[84:99], v[72:75], v[76:79], v[84:99]
    s_waitcnt lgkmcnt(2)
    v_mfma_f32_32x32x16_bf16 v[84:99], v[36:39], v[40:43], v[84:99]
    v_xor_b32 v30, s32, v26
    ds_read_b128 v[60:63], v30
    ds_read_b64_tr_b16 v[64:65], v32 offset:28672
    ds_read_b64_tr_b16 v[66:67], v32 offset:29184
    s_waitcnt lgkmcnt(3)
    v_mfma_f32_32x32x16_bf16 v[84:99], v[48:51], v[52:55], v[84:99]
    v_xor_b32 v31, s32, v27
    ds_read_b128 v[72:75], v31
    ds_read_b64_tr_b16 v[76:77], v32 offset:30720
    ds_read_b64_tr_b16 v[78:79], v32 offset:31232
    s_add_u32 s31, s65, 256
    s_and_b32 s31, s31, 0x380
    v_xor_b32 v28, s31, v24
    ds_read_b128 v[36:39], v28
    v_xor_b32 v29, s31, v25
    ds_read_b128 v[48:51], v29
    s_waitcnt lgkmcnt(5)
    v_mfma_f32_32x32x16_bf16 v[84:99], v[60:63], v[64:67], v[84:99]
    s_waitcnt lgkmcnt(2)
    s_barrier
    ds_read_b64_tr_b16 v[40:41], v33 offset:0
    ds_read_b64_tr_b16 v[42:43], v33 offset:512
    ds_read_b64_tr_b16 v[52:53], v33 offset:2048
    ds_read_b64_tr_b16 v[54:55], v33 offset:2560
    v_mfma_f32_32x32x16_bf16 v[84:99], v[72:75], v[76:79], v[84:99]
    s_waitcnt lgkmcnt(2)
    v_mfma_f32_32x32x16_bf16 v[84:99], v[36:39], v[40:43], v[84:99]
    v_xor_b32 v30, s31, v26
    ds_read_b128 v[60:63], v30
    ds_read_b64_tr_b16 v[64:65], v33 offset:4096
    ds_read_b64_tr_b16 v[66:67], v33 offset:4608
    s_waitcnt lgkmcnt(3)
    v_mfma_f32_32x32x16_bf16 v[84:99], v[48:51], v[52:55], v[84:99]
    v_xor_b32 v31, s31, v27
    ds_read_b128 v[72:75], v31
    ds_read_b64_tr_b16 v[76:77], v33 offset:6144
    ds_read_b64_tr_b16 v[78:79], v33 offset:6656
    s_add_u32 s32, s65, 384
    s_and_b32 s32, s32, 0x380
    v_xor_b32 v28, s32, v24
    ds_read_b128 v[36:39], v28
    v_xor_b32 v29, s32, v25
    ds_read_b128 v[48:51], v29
    s_waitcnt lgkmcnt(5)
    v_mfma_f32_32x32x16_bf16 v[84:99], v[60:63], v[64:67], v[84:99]
    s_waitcnt lgkmcnt(2)
    s_barrier
    ds_read_b64_tr_b16 v[40:41], v33 offset:24576
    ds_read_b64_tr_b16 v[42:43], v33 offset:25088
    ds_read_b64_tr_b16 v[52:53], v33 offset:26624
    ds_read_b64_tr_b16 v[54:55], v33 offset:27136
    v_mfma_f32_32x32x16_bf16 v[84:99], v[72:75], v[76:79], v[84:99]
    s_waitcnt lgkmcnt(2)
    v_mfma_f32_32x32x16_bf16 v[84:99], v[36:39], v[40:43], v[84:99]
    v_xor_b32 v30, s32, v26
    ds_read_b128 v[60:63], v30
    ds_read_b64_tr_b16 v[64:65], v33 offset:28672
    ds_read_b64_tr_b16 v[66:67], v33 offset:29184
    s_waitcnt lgkmcnt(3)
    v_mfma_f32_32x32x16_bf16 v[84:99], v[48:51], v[52:55], v[84:99]
    v_xor_b32 v31, s32, v27
    ds_read_b128 v[72:75], v31
    ds_read_b64_tr_b16 v[76:77], v33 offset:30720
    ds_read_b64_tr_b16 v[78:79], v33 offset:31232
    s_add_u32 s31, s65, 512
    s_and_b32 s31, s31, 0x380
    v_xor_b32 v28, s31, v24
    ds_read_b128 v[36:39], v28
    v_xor_b32 v29, s31, v25
    ds_read_b128 v[48:51], v29
    s_waitcnt lgkmcnt(5)
    v_mfma_f32_32x32x16_bf16 v[84:99], v[60:63], v[64:67], v[84:99]
    s_waitcnt lgkmcnt(2)
    s_barrier
    ds_read_b64_tr_b16 v[40:41], v32 offset:0
    ds_read_b64_tr_b16 v[42:43], v32 offset:512
    ds_read_b64_tr_b16 v[52:53], v32 offset:2048
    ds_read_b64_tr_b16 v[54:55], v32 offset:2560
    v_mfma_f32_32x32x16_bf16 v[84:99], v[72:75], v[76:79], v[84:99]
    s_waitcnt lgkmcnt(2)
    v_mfma_f32_32x32x16_bf16 v[84:99], v[36:39], v[40:43], v[84:99]
    v_xor_b32 v30, s31, v26
    ds_read_b128 v[60:63], v30
    ds_read_b64_tr_b16 v[64:65], v32 offset:4096
    ds_read_b64_tr_b16 v[66:67], v32 offset:4608
    s_waitcnt lgkmcnt(3)
    v_mfma_f32_32x32x16_bf16 v[84:99], v[48:51], v[52:55], v[84:99]
    v_xor_b32 v31, s31, v27
    ds_read_b128 v[72:75], v31
    ds_read_b64_tr_b16 v[76:77], v32 offset:6144
    ds_read_b64_tr_b16 v[78:79], v32 offset:6656
    s_add_u32 s32, s65, 640
    s_and_b32 s32, s32, 0x380
    v_xor_b32 v28, s32, v24
    ds_read_b128 v[36:39], v28
    v_xor_b32 v29, s32, v25
    ds_read_b128 v[48:51], v29
    s_waitcnt lgkmcnt(5)
    v_mfma_f32_32x32x16_bf16 v[84:99], v[60:63], v[64:67], v[84:99]
    s_waitcnt lgkmcnt(2)
    s_barrier
    ds_read_b64_tr_b16 v[40:41], v32 offset:24576
    ds_read_b64_tr_b16 v[42:43], v32 offset:25088
    ds_read_b64_tr_b16 v[52:53], v32 offset:26624
    ds_read_b64_tr_b16 v[54:55], v32 offset:27136
    v_mfma_f32_32x32x16_bf16 v[84:99], v[72:75], v[76:79], v[84:99]
    s_waitcnt lgkmcnt(2)
    v_mfma_f32_32x32x16_bf16 v[84:99], v[36:39], v[40:43], v[84:99]
    v_xor_b32 v30, s32, v26
    ds_read_b128 v[60:63], v30
    ds_read_b64_tr_b16 v[64:65], v32 offset:28672
    ds_read_b64_tr_b16 v[66:67], v32 offset:29184
    s_waitcnt lgkmcnt(3)
    v_mfma_f32_32x32x16_bf16 v[84:99], v[48:51], v[52:55], v[84:99]
    v_xor_b32 v31, s32, v27
    ds_read_b128 v[72:75], v31
    ds_read_b64_tr_b16 v[76:77], v32 offset:30720
    ds_read_b64_tr_b16 v[78:79], v32 offset:31232
    s_add_u32 s31, s65, 768
    s_and_b32 s31, s31, 0x380
    v_xor_b32 v28, s31, v24
    ds_read_b128 v[36:39], v28
    v_xor_b32 v29, s31, v25
    ds_read_b128 v[48:51], v29
    s_waitcnt lgkmcnt(5)
    v_mfma_f32_32x32x16_bf16 v[84:99], v[60:63], v[64:67], v[84:99]
    s_waitcnt lgkmcnt(2)
    s_barrier
    ds_read_b64_tr_b16 v[40:41], v33 offset:0
    ds_read_b64_tr_b16 v[42:43], v33 offset:512
    ds_read_b64_tr_b16 v[52:53], v33 offset:2048
    ds_read_b64_tr_b16 v[54:55], v33 offset:2560
    v_mfma_f32_32x32x16_bf16 v[84:99], v[72:75], v[76:79], v[84:99]
    s_waitcnt lgkmcnt(2)
    v_mfma_f32_32x32x16_bf16 v[84:99], v[36:39], v[40:43], v[84:99]
    v_xor_b32 v30, s31, v26
    ds_read_b128 v[60:63], v30
    ds_read_b64_tr_b16 v[64:65], v33 offset:4096
    ds_read_b64_tr_b16 v[66:67], v33 offset:4608
    s_waitcnt lgkmcnt(3)
    v_mfma_f32_32x32x16_bf16 v[84:99], v[48:51], v[52:55], v[84:99]
    v_xor_b32 v31, s31, v27
    ds_read_b128 v[72:75], v31
    ds_read_b64_tr_b16 v[76:77], v33 offset:6144
    ds_read_b64_tr_b16 v[78:79], v33 offset:6656
    s_add_u32 s32, s65, 896
    s_and_b32 s32, s32, 0x380
    v_xor_b32 v28, s32, v24
    ds_read_b128 v[36:39], v28
    v_xor_b32 v29, s32, v25
    ds_read_b128 v[48:51], v29
    s_waitcnt lgkmcnt(5)
    v_mfma_f32_32x32x16_bf16 v[84:99], v[60:63], v[64:67], v[84:99]
    s_waitcnt lgkmcnt(2)
    s_barrier
    ds_read_b64_tr_b16 v[40:41], v33 offset:24576
    ds_read_b64_tr_b16 v[42:43], v33 offset:25088
    ds_read_b64_tr_b16 v[52:53], v33 offset:26624
    ds_read_b64_tr_b16 v[54:55], v33 offset:27136
    v_mfma_f32_32x32x16_bf16 v[84:99], v[72:75], v[76:79], v[84:99]
    s_lshl_b32 s60, s25, 1
    s_add_u32 s60, s60, s56
    s_lshl_b32 s61, s26, 1
    s_add_u32 s61, s61, s57
    s_lshl_b32 s61, s61, 17
    s_lshl_b32 s29, s60, 10
    s_add_u32 s61, s61, s29
    s_add_u32 s61, s61, 0
    v_lshlrev_b32 v3, 4, v2
    v_bfe_u32 v4, v2, 4, 1
    v_lshlrev_b32 v4, 16, v4
    v_and_b32 v5, 15, v2
    v_lshl_add_u32 v4, v5, 4, v4
    v_lshrrev_b32 v5, 5, v2
    v_lshl_add_u32 v4, v5, 8, v4
    s_add_u32 s63, s61, 4194304
    s_waitcnt lgkmcnt(2)
    v_mfma_f32_32x32x16_bf16 v[84:99], v[36:39], v[40:43], v[84:99]
    v_xor_b32 v30, s32, v26
    ds_read_b128 v[60:63], v30
    ds_read_b64_tr_b16 v[64:65], v33 offset:28672
    ds_read_b64_tr_b16 v[66:67], v33 offset:29184
    s_waitcnt lgkmcnt(3)
    v_mfma_f32_32x32x16_bf16 v[84:99], v[48:51], v[52:55], v[84:99]
    v_xor_b32 v31, s32, v27
    ds_read_b128 v[72:75], v31
    ds_read_b64_tr_b16 v[76:77], v33 offset:30720
    ds_read_b64_tr_b16 v[78:79], v33 offset:31232
    s_add_u32 s31, s65, 0
    s_and_b32 s31, s31, 0x380
    v_xor_b32 v28, s31, v24
    ds_read_b128 v[36:39], v28
    v_xor_b32 v29, s31, v25
    ds_read_b128 v[48:51], v29
    s_waitcnt lgkmcnt(5)
    v_mfma_f32_32x32x16_bf16 v[84:99], v[60:63], v[64:67], v[84:99]
    s_waitcnt lgkmcnt(2)
    s_barrier
    ds_read_b64_tr_b16 v[40:41], v32 offset:0
    ds_read_b64_tr_b16 v[42:43], v32 offset:512
    ds_read_b64_tr_b16 v[52:53], v32 offset:2048
    ds_read_b64_tr_b16 v[54:55], v32 offset:2560
    v_mfma_f32_32x32x16_bf16 v[84:99], v[72:75], v[76:79], v[84:99]
    v_mfma_f32_32x32x16_bf16 v[116:131], v[12:15], v[20:23], 0
    s_waitcnt lgkmcnt(2)
    v_mfma_f32_32x32x16_bf16 v[116:131], v[40:43], v[36:39], v[116:131]
    v_xor_b32 v30, s31, v26
    ds_read_b128 v[60:63], v30
    ds_read_b64_tr_b16 v[64:65], v32 offset:4096
    ds_read_b64_tr_b16 v[66:67], v32 offset:4608
    s_waitcnt lgkmcnt(3)
    v_mfma_f32_32x32x16_bf16 v[116:131], v[52:55], v[48:51], v[116:131]
    v_xor_b32 v31, s31, v27
    ds_read_b128 v[72:75], v31
    ds_read_b64_tr_b16 v[76:77], v32 offset:6144
    ds_read_b64_tr_b16 v[78:79], v32 offset:6656
    s_nop 3
    v_cvt_pk_bf16_f32 v148, v84, v85
    v_cvt_pk_bf16_f32 v149, v86, v87
    v_cvt_pk_bf16_f32 v150, v88, v89
    v_cvt_pk_bf16_f32 v151, v90, v91
    v_cvt_pk_bf16_f32 v152, v92, v93
    v_cvt_pk_bf16_f32 v153, v94, v95
    v_cvt_pk_bf16_f32 v154, v96, v97
    v_cvt_pk_bf16_f32 v155, v98, v99
    s_add_u32 s32, s65, 128
    s_and_b32 s32, s32, 0x380
    v_xor_b32 v28, s32, v24
    ds_read_b128 v[36:39], v28
    v_xor_b32 v29, s32, v25
    ds_read_b128 v[48:51], v29
    s_waitcnt lgkmcnt(5)
    v_mfma_f32_32x32x16_bf16 v[116:131], v[64:67], v[60:63], v[116:131]
    buffer_store_dwordx4 v[148:151], v4, s[36:39], s63 offen sc1
    s_waitcnt lgkmcnt(2)
    s_barrier
    ds_read_b64_tr_b16 v[40:41], v32 offset:24576
    ds_read_b64_tr_b16 v[42:43], v32 offset:25088
    ds_read_b64_tr_b16 v[52:53], v32 offset:26624
    ds_read_b64_tr_b16 v[54:55], v32 offset:27136
    v_mfma_f32_32x32x16_bf16 v[116:131], v[76:79], v[72:75], v[116:131]
    s_waitcnt lgkmcnt(2)
    v_mfma_f32_32x32x16_bf16 v[116:131], v[40:43], v[36:39], v[116:131]
    v_xor_b32 v30, s32, v26
    ds_read_b128 v[60:63], v30
    ds_read_b64_tr_b16 v[64:65], v32 offset:28672
    ds_read_b64_tr_b16 v[66:67], v32 offset:29184
    s_mov_b32 s44, s18
    s_mov_b32 s45, s19
    s_mov_b32 s46, 1024
    v_lshrrev_b32 v9, 3, v0
    s_lshl_b32 s29, s25, 6
    v_add_u32 v20, s29, v9
    v_and_b32 v10, 7, v0
    s_lshl_b32 s29, s26, 7
    v_lshl_add_u32 v23, v10, 4, s29
    v_lshl_add_u32 v20, v20, 10, v23
    v_mov_b32 v16, v23
    v_lshlrev_b32 v23, 1, v10
    s_waitcnt lgkmcnt(3)
    v_mfma_f32_32x32x16_bf16 v[116:131], v[52:55], v[48:51], v[116:131]
    v_xor_b32 v31, s32, v27
    ds_read_b128 v[72:75], v31
    ds_read_b64_tr_b16 v[76:77], v32 offset:30720
    ds_read_b64_tr_b16 v[78:79], v32 offset:31232
    v_and_b32 v10, 15, v9
    v_xor_b32 v23, v23, v10
    v_lshlrev_b32 v23, 4, v23
    v_lshl_add_u32 v23, v9, 8, v23
    s_and_b32 s4, s24, 1
    s_lshr_b32 s5, s24, 1
    s_lshl_b32 s29, s25, 1
    s_add_u32 s29, s29, s4
    s_mul_i32 s10, s29, 120832
    s_lshl_b32 s29, s5, 13
    s_add_u32 s10, s10, s29
    s_add_u32 s10, s10, 6291456
    s_add_u32 s11, s10, 4096
    s_lshl_b32 s29, s28, 3
    s_add_u32 s29, s29, s24
    s_mul_i32 s29, s29, 120832
    s_lshl_b32 s30, s27, 10
    s_add_u32 s29, s29, s30
    s_add_u32 s3, s29, 6291456
    v_lshlrev_b32 v1, 10, v2
    v_add_u32 v1, 1020, v1
    v_lshrrev_b32 v9, 5, v2
    s_add_u32 s31, s65, 256
    s_and_b32 s31, s31, 0x380
    v_xor_b32 v28, s31, v24
    ds_read_b128 v[36:39], v28
    v_xor_b32 v29, s31, v25
    ds_read_b128 v[48:51], v29
    s_waitcnt lgkmcnt(5)
    v_mfma_f32_32x32x16_bf16 v[116:131], v[64:67], v[60:63], v[116:131]
    buffer_store_dwordx4 v[152:155], v4, s[36:39], s63 offen offset:512 sc1
    s_waitcnt lgkmcnt(2)
    s_barrier
    ds_read_b64_tr_b16 v[40:41], v33 offset:0
    ds_read_b64_tr_b16 v[42:43], v33 offset:512
    ds_read_b64_tr_b16 v[52:53], v33 offset:2048
    ds_read_b64_tr_b16 v[54:55], v33 offset:2560
    v_mfma_f32_32x32x16_bf16 v[116:131], v[76:79], v[72:75], v[116:131]
    s_waitcnt lgkmcnt(2)
    v_mfma_f32_32x32x16_bf16 v[116:131], v[40:43], v[36:39], v[116:131]
    v_xor_b32 v30, s31, v26
    ds_read_b128 v[60:63], v30
    ds_read_b64_tr_b16 v[64:65], v33 offset:4096
    ds_read_b64_tr_b16 v[66:67], v33 offset:4608
    v_bfe_u32 v21, v2, 2, 2
    v_lshl_add_u32 v21, v9, 2, v21
    v_lshlrev_b32 v21, 7, v21
    v_bfe_u32 v10, v2, 3, 1
    v_lshl_add_u32 v21, v10, 6, v21
    v_bfe_u32 v10, v2, 4, 1
    v_lshl_add_u32 v21, v10, 5, v21
    s_waitcnt lgkmcnt(3)
    v_mfma_f32_32x32x16_bf16 v[116:131], v[52:55], v[48:51], v[116:131]
    v_xor_b32 v31, s31, v27
    ds_read_b128 v[72:75], v31
    ds_read_b64_tr_b16 v[76:77], v33 offset:6144
    ds_read_b64_tr_b16 v[78:79], v33 offset:6656
    v_and_b32 v10, 3, v2
    v_lshl_add_u32 v21, v10, 3, v21
    s_and_b32 s30, s5, 1
    s_lshl_b32 s30, s30, 14
    s_add_u32 s29, s30, 131072
    s_cmp_lt_u32 s5, 2
    s_cselect_b32 s30, s29, s30
    v_add_u32 v21, s30, v21
    v_and_b32 v22, 31, v2
    s_lshl_b32 s29, s4, 5
    v_add_u32 v22, s29, v22
    v_and_b32 v10, 15, v22
    v_xor_b32 v10, v9, v10
    s_add_u32 s32, s65, 384
    s_and_b32 s32, s32, 0x380
    v_xor_b32 v28, s32, v24
    ds_read_b128 v[36:39], v28
    v_xor_b32 v29, s32, v25
    ds_read_b128 v[48:51], v29
    s_waitcnt lgkmcnt(5)
    v_mfma_f32_32x32x16_bf16 v[116:131], v[64:67], v[60:63], v[116:131]
    s_waitcnt lgkmcnt(2)
    s_barrier
    ds_read_b64_tr_b16 v[40:41], v33 offset:24576
    ds_read_b64_tr_b16 v[42:43], v33 offset:25088
    ds_read_b64_tr_b16 v[52:53], v33 offset:26624
    ds_read_b64_tr_b16 v[54:55], v33 offset:27136
    v_mfma_f32_32x32x16_bf16 v[116:131], v[76:79], v[72:75], v[116:131]
    s_waitcnt lgkmcnt(2)
    v_mfma_f32_32x32x16_bf16 v[116:131], v[40:43], v[36:39], v[116:131]
    v_xor_b32 v30, s32, v26
    ds_read_b128 v[60:63], v30
    ds_read_b64_tr_b16 v[64:65], v33 offset:28672
    ds_read_b64_tr_b16 v[66:67], v33 offset:29184
    v_lshlrev_b32 v10, 4, v10
    v_lshl_add_u32 v22, v22, 8, v10
    v_add_u32 v22, s30, v22
    s_mov_b32 s48, s20
    s_mov_b32 s49, s21
    s_mov_b32 s50, 2097152
    s_mov_b32 s51, 0x00020000
    v_mov_b32 v6, 0xdddddddd
    s_mov_b32 s66, 0x0000ffff
    s_mov_b32 s67, 0x0000ffff
    v_and_b32 v10, 15, v2
    v_lshlrev_b32 v9, 8, v9
    v_lshl_add_u32 v9, v10, 4, v9
    s_waitcnt lgkmcnt(3)
    v_mfma_f32_32x32x16_bf16 v[116:131], v[52:55], v[48:51], v[116:131]
    v_xor_b32 v31, s32, v27
    ds_read_b128 v[72:75], v31
    ds_read_b64_tr_b16 v[76:77], v33 offset:30720
    ds_read_b64_tr_b16 v[78:79], v33 offset:31232
    v_add_u32 v7, 65536, v9
    v_and_b32 v10, 27, v2
    v_cmp_eq_u32 vcc, 16, v10
    v_mov_b32 v9, 0x3f803f80
    s_lshl_b32 s29, s24, 10
    s_add_u32 s29, s29, 131072
    v_cndmask_b32 v9, 0, v9, vcc
    v_add_u32 v8, s29, v3
    v_mov_b32 v92, v9
    s_add_u32 s31, s65, 512
    s_and_b32 s31, s31, 0x380
    v_xor_b32 v28, s31, v24
    ds_read_b128 v[36:39], v28
    v_xor_b32 v29, s31, v25
    ds_read_b128 v[48:51], v29
    s_waitcnt lgkmcnt(5)
    v_mfma_f32_32x32x16_bf16 v[116:131], v[64:67], v[60:63], v[116:131]
    s_waitcnt lgkmcnt(2)
    s_barrier
    ds_read_b64_tr_b16 v[40:41], v32 offset:0
    ds_read_b64_tr_b16 v[42:43], v32 offset:512
    ds_read_b64_tr_b16 v[52:53], v32 offset:2048
    ds_read_b64_tr_b16 v[54:55], v32 offset:2560
    v_mfma_f32_32x32x16_bf16 v[116:131], v[76:79], v[72:75], v[116:131]
    s_waitcnt lgkmcnt(2)
    v_mfma_f32_32x32x16_bf16 v[116:131], v[40:43], v[36:39], v[116:131]
    v_xor_b32 v30, s31, v26
    ds_read_b128 v[60:63], v30
    ds_read_b64_tr_b16 v[64:65], v32 offset:4096
    ds_read_b64_tr_b16 v[66:67], v32 offset:4608
    v_mov_b32 v96, v9
    v_mov_b32 v88, 0
    v_mov_b32 v93, v9
    v_mov_b32 v97, v9
    v_mov_b32 v89, 0
    v_mov_b32 v94, v9
    v_mov_b32 v98, v9
    s_waitcnt lgkmcnt(3)
    v_mfma_f32_32x32x16_bf16 v[116:131], v[52:55], v[48:51], v[116:131]
    v_xor_b32 v31, s31, v27
    ds_read_b128 v[72:75], v31
    ds_read_b64_tr_b16 v[76:77], v32 offset:6144
    ds_read_b64_tr_b16 v[78:79], v32 offset:6656
    v_mov_b32 v90, 0
    v_mov_b32 v95, v9
    v_mov_b32 v99, v9
    v_mov_b32 v91, 0
    s_add_u32 s32, s65, 640
    s_and_b32 s32, s32, 0x380
    v_xor_b32 v28, s32, v24
    ds_read_b128 v[36:39], v28
    v_xor_b32 v29, s32, v25
    ds_read_b128 v[48:51], v29
    s_waitcnt lgkmcnt(5)
    v_mfma_f32_32x32x16_bf16 v[116:131], v[64:67], v[60:63], v[116:131]
    s_waitcnt lgkmcnt(2)
    s_waitcnt vmcnt(0)
    s_barrier
    ds_read_b64_tr_b16 v[40:41], v32 offset:24576
    ds_read_b64_tr_b16 v[42:43], v32 offset:25088
    ds_read_b64_tr_b16 v[52:53], v32 offset:26624
    ds_read_b64_tr_b16 v[54:55], v32 offset:27136
    v_mfma_f32_32x32x16_bf16 v[116:131], v[76:79], v[72:75], v[116:131]
    s_waitcnt lgkmcnt(2)
    v_mfma_f32_32x32x16_bf16 v[116:131], v[40:43], v[36:39], v[116:131]
    v_xor_b32 v30, s32, v26
    ds_read_b128 v[60:63], v30
    ds_read_b64_tr_b16 v[64:65], v32 offset:28672
    ds_read_b64_tr_b16 v[66:67], v32 offset:29184
    s_waitcnt lgkmcnt(3)
    v_mfma_f32_32x32x16_bf16 v[116:131], v[52:55], v[48:51], v[116:131]
    v_xor_b32 v31, s32, v27
    ds_read_b128 v[72:75], v31
    ds_read_b64_tr_b16 v[76:77], v32 offset:30720
    ds_read_b64_tr_b16 v[78:79], v32 offset:31232
    s_add_u32 s31, s65, 768
    s_and_b32 s31, s31, 0x380
    v_xor_b32 v28, s31, v24
    ds_read_b128 v[36:39], v28
    v_xor_b32 v29, s31, v25
    ds_read_b128 v[48:51], v29
    s_waitcnt lgkmcnt(5)
    v_mfma_f32_32x32x16_bf16 v[116:131], v[64:67], v[60:63], v[116:131]
    s_waitcnt lgkmcnt(2)
    s_barrier
    ds_read_b64_tr_b16 v[40:41], v33 offset:0
    ds_read_b64_tr_b16 v[42:43], v33 offset:512
    ds_read_b64_tr_b16 v[52:53], v33 offset:2048
    ds_read_b64_tr_b16 v[54:55], v33 offset:2560
    v_mfma_f32_32x32x16_bf16 v[116:131], v[76:79], v[72:75], v[116:131]
    s_waitcnt lgkmcnt(2)
    v_mfma_f32_32x32x16_bf16 v[116:131], v[40:43], v[36:39], v[116:131]
    v_xor_b32 v30, s31, v26
    ds_read_b128 v[60:63], v30
    ds_read_b64_tr_b16 v[64:65], v33 offset:4096
    ds_read_b64_tr_b16 v[66:67], v33 offset:4608
    s_waitcnt lgkmcnt(3)
    v_mfma_f32_32x32x16_bf16 v[116:131], v[52:55], v[48:51], v[116:131]
    v_xor_b32 v31, s31, v27
    ds_read_b128 v[72:75], v31
    ds_read_b64_tr_b16 v[76:77], v33 offset:6144
    ds_read_b64_tr_b16 v[78:79], v33 offset:6656
    s_add_u32 s32, s65, 896
    s_and_b32 s32, s32, 0x380
    v_xor_b32 v28, s32, v24
    ds_read_b128 v[36:39], v28
    v_xor_b32 v29, s32, v25
    ds_read_b128 v[48:51], v29
    s_waitcnt lgkmcnt(5)
    v_mfma_f32_32x32x16_bf16 v[116:131], v[64:67], v[60:63], v[116:131]
    s_waitcnt lgkmcnt(2)
    s_barrier
    ds_read_b64_tr_b16 v[40:41], v33 offset:24576
    ds_read_b64_tr_b16 v[42:43], v33 offset:25088
    ds_read_b64_tr_b16 v[52:53], v33 offset:26624
    ds_read_b64_tr_b16 v[54:55], v33 offset:27136
    v_mfma_f32_32x32x16_bf16 v[116:131], v[76:79], v[72:75], v[116:131]
    s_waitcnt lgkmcnt(2)
    v_mfma_f32_32x32x16_bf16 v[116:131], v[40:43], v[36:39], v[116:131]
    v_xor_b32 v30, s32, v26
    ds_read_b128 v[60:63], v30
    ds_read_b64_tr_b16 v[64:65], v33 offset:28672
    ds_read_b64_tr_b16 v[66:67], v33 offset:29184
    s_waitcnt lgkmcnt(3)
    v_mfma_f32_32x32x16_bf16 v[116:131], v[52:55], v[48:51], v[116:131]
    v_xor_b32 v31, s32, v27
    ds_read_b128 v[72:75], v31
    ds_read_b64_tr_b16 v[76:77], v33 offset:30720
    ds_read_b64_tr_b16 v[78:79], v33 offset:31232
    s_waitcnt lgkmcnt(3)
    v_mfma_f32_32x32x16_bf16 v[116:131], v[64:67], v[60:63], v[116:131]
    s_waitcnt lgkmcnt(0)
    s_barrier
    v_mfma_f32_32x32x16_bf16 v[116:131], v[76:79], v[72:75], v[116:131]
    v_mov_b32 v36, 0xbdd2d3e8
    v_mov_b32 v37, 0xc0135761
    s_mul_i32 s30, s56, 12288
    s_lshl_b32 s29, s57, 11
    s_add_u32 s29, s29, s30
    s_add_u32 s29, s29, 147456
    v_add_u32 v5, s29, v3
    s_nop 6
    s_add_u32 s30, s59, 0
    s_cmp_ge_u32 s30, 1376
    s_cbranch_scc1 M_skip_11
    v_pk_mul_f32 v[48:49], v[116:117], v[116:117]
    v_pk_mul_f32 v[50:51], v[118:119], v[118:119]
    v_pk_mul_f32 v[52:53], v[120:121], v[120:121]
    v_pk_mul_f32 v[54:55], v[122:123], v[122:123]
    v_pk_mul_f32 v[56:57], v[124:125], v[124:125]
    v_pk_mul_f32 v[58:59], v[126:127], v[126:127]
    v_pk_mul_f32 v[60:61], v[128:129], v[128:129]
    v_pk_mul_f32 v[62:63], v[130:131], v[130:131]
    v_pk_fma_f32 v[48:49], v[48:49], v[36:37], v[36:37] op_sel:[0,0,1] op_sel_hi:[1,0,1]
    v_pk_fma_f32 v[50:51], v[50:51], v[36:37], v[36:37] op_sel:[0,0,1] op_sel_hi:[1,0,1]
    v_pk_fma_f32 v[52:53], v[52:53], v[36:37], v[36:37] op_sel:[0,0,1] op_sel_hi:[1,0,1]
    v_pk_fma_f32 v[54:55], v[54:55], v[36:37], v[36:37] op_sel:[0,0,1] op_sel_hi:[1,0,1]
    v_pk_fma_f32 v[56:57], v[56:57], v[36:37], v[36:37] op_sel:[0,0,1] op_sel_hi:[1,0,1]
    v_pk_fma_f32 v[58:59], v[58:59], v[36:37], v[36:37] op_sel:[0,0,1] op_sel_hi:[1,0,1]
    v_pk_fma_f32 v[60:61], v[60:61], v[36:37], v[36:37] op_sel:[0,0,1] op_sel_hi:[1,0,1]
    v_pk_fma_f32 v[62:63], v[62:63], v[36:37], v[36:37] op_sel:[0,0,1] op_sel_hi:[1,0,1]
    v_pk_mul_f32 v[48:49], v[48:49], v[116:117]
    v_pk_mul_f32 v[50:51], v[50:51], v[118:119]
    v_pk_mul_f32 v[52:53], v[52:53], v[120:121]
    v_pk_mul_f32 v[54:55], v[54:55], v[122:123]
    v_pk_mul_f32 v[56:57], v[56:57], v[124:125]
    v_pk_mul_f32 v[58:59], v[58:59], v[126:127]
    v_pk_mul_f32 v[60:61], v[60:61], v[128:129]
    v_pk_mul_f32 v[62:63], v[62:63], v[130:131]
    v_exp_f32 v48, v48
    v_exp_f32 v49, v49
    v_exp_f32 v50, v50
    v_exp_f32 v51, v51
    v_exp_f32 v52, v52
    v_exp_f32 v53, v53
    v_exp_f32 v54, v54
    v_exp_f32 v55, v55
    v_exp_f32 v56, v56
    v_exp_f32 v57, v57
    v_exp_f32 v58, v58
    v_exp_f32 v59, v59
    v_exp_f32 v60, v60
    v_exp_f32 v61, v61
    v_exp_f32 v62, v62
    v_exp_f32 v63, v63
    v_pk_add_f32 v[48:49], v[48:49], 1.0 op_sel_hi:[1,0]
    v_pk_add_f32 v[50:51], v[50:51], 1.0 op_sel_hi:[1,0]
    v_pk_add_f32 v[52:53], v[52:53], 1.0 op_sel_hi:[1,0]
    v_pk_add_f32 v[54:55], v[54:55], 1.0 op_sel_hi:[1,0]
    v_pk_add_f32 v[56:57], v[56:57], 1.0 op_sel_hi:[1,0]
    v_pk_add_f32 v[58:59], v[58:59], 1.0 op_sel_hi:[1,0]
    v_pk_add_f32 v[60:61], v[60:61], 1.0 op_sel_hi:[1,0]
    v_pk_add_f32 v[62:63], v[62:63], 1.0 op_sel_hi:[1,0]
    v_rcp_f32 v48, v48
    v_rcp_f32 v49, v49
    v_rcp_f32 v50, v50
    v_rcp_f32 v51, v51
    v_rcp_f32 v52, v52
    v_rcp_f32 v53, v53
    v_rcp_f32 v54, v54
    v_rcp_f32 v55, v55
    v_rcp_f32 v56, v56
    v_rcp_f32 v57, v57
    v_rcp_f32 v58, v58
    v_rcp_f32 v59, v59
    v_rcp_f32 v60, v60
    v_rcp_f32 v61, v61
    v_rcp_f32 v62, v62
    v_rcp_f32 v63, v63
    v_pk_mul_f32 v[48:49], v[48:49], v[116:117]
    v_pk_mul_f32 v[50:51], v[50:51], v[118:119]
    v_pk_mul_f32 v[52:53], v[52:53], v[120:121]
    v_pk_mul_f32 v[54:55], v[54:55], v[122:123]
    v_pk_mul_f32 v[56:57], v[56:57], v[124:125]
    v_pk_mul_f32 v[58:59], v[58:59], v[126:127]
    v_pk_mul_f32 v[60:61], v[60:61], v[128:129]
    v_pk_mul_f32 v[62:63], v[62:63], v[130:131]
    v_cvt_pk_bf16_f32 v148, v48, v49
    v_cvt_pk_bf16_f32 v149, v50, v51
    v_cvt_pk_bf16_f32 v150, v52, v53
    v_cvt_pk_bf16_f32 v151, v54, v55
    v_cvt_pk_bf16_f32 v152, v56, v57
    v_cvt_pk_bf16_f32 v153, v58, v59
    v_cvt_pk_bf16_f32 v154, v60, v61
    v_cvt_pk_bf16_f32 v155, v62, v63
    ds_write_b128 v5, v[148:151] offset:0
    ds_write_b128 v5, v[152:155] offset:1024
M_skip_11:
M_JOIN_4:
    s_waitcnt lgkmcnt(0)
    v_mfma_f32_32x32x16_bf16 v[36:51], v[88:91], v[88:91], 0
    v_mfma_f32_32x32x16_bf16 v[132:147], v[88:91], v[88:91], 0
    v_mov_b32 v4, v3
    v_mov_b32 v5, v7
    s_mov_b32 s33, 0
    s_mov_b32 s56, 3
    s_waitcnt lgkmcnt(0)
    s_barrier
    ds_read_b128 v[84:87], v8
    ds_read_b128 v[88:91], v3
    s_mov_b64 exec, s[66:67]
    ds_read_b128 v[96:99], v5
    s_mov_b64 exec, -1
    s_waitcnt lgkmcnt(1)
    v_mfma_f32_32x32x16_bf16 v[116:131], v[88:91], v[84:87], 0
    s_nop 11
    v_max3_f32 v8, v116, v117, v118
    v_max3_f32 v9, v119, v120, v121
    v_max3_f32 v8, v8, v122, v123
    v_max3_f32 v9, v9, v124, v125
    v_max3_f32 v8, v8, v126, v127
    v_max3_f32 v9, v9, v128, v129
    v_max3_f32 v8, v8, v130, v131
    v_max_f32 v8, v8, v9
    v_mov_b32 v9, v8
    s_nop 1
    v_permlane32_swap_b32 v8, v9
    s_nop 0
    v_min_f32 v100, -v8, -v9
    v_mov_b32 v101, v100
    v_pk_mov_b32 v[102:103], v[100:101], v[100:101]
    v_pk_mov_b32 v[104:105], v[100:101], v[100:101]
    v_pk_mov_b32 v[106:107], v[100:101], v[100:101]
    v_pk_mov_b32 v[108:109], v[100:101], v[100:101]
    v_pk_mov_b32 v[110:111], v[100:101], v[100:101]
    v_pk_mov_b32 v[112:113], v[100:101], v[100:101]
    v_pk_mov_b32 v[114:115], v[100:101], v[100:101]
    s_nop 1
    v_mfma_f32_32x32x16_bf16 v[116:131], v[88:91], v[84:87], v[100:115]
    ds_read_b128 v[88:91], v4 offset:1024
    s_mov_b64 exec, s[66:67]
    ds_read_b128 v[92:95], v5
    s_mov_b64 exec, -1
    s_nop 4
.p2align 3
AT_LOOP_12:
    s_cmp_eq_u32 s33, s56
    s_cbranch_scc1 AT_nob_13B
AT_nob_13:
    s_setprio 3
    v_exp_f32 v116, v116
    v_exp_f32 v117, v117
    s_waitcnt lgkmcnt(2)
    v_smfmac_f32_32x32x32_bf16 v[36:51], v[96:99], v[140:147], v6
    s_mov_b64 exec, s[66:67]
    ds_read_b128 v[96:99], v5 offset:512
    s_mov_b64 exec, -1
    v_exp_f32 v118, v118
    v_exp_f32 v119, v119
    v_exp_f32 v120, v120
    v_exp_f32 v121, v121
    s_waitcnt lgkmcnt(2)
    v_mfma_f32_32x32x16_bf16 v[132:147], v[88:91], v[84:87], v[100:115]
    ds_read_b128 v[88:91], v4 offset:2048
    v_exp_f32 v122, v122
    v_exp_f32 v123, v123
    v_exp_f32 v124, v124
    v_exp_f32 v125, v125
    v_exp_f32 v126, v126
    s_waitcnt lgkmcnt(2)
    v_smfmac_f32_32x32x32_bf16 v[36:51], v[92:95], v[116:123], v6
    s_mov_b64 exec, s[66:67]
    ds_read_b128 v[92:95], v5 offset:1024
    s_mov_b64 exec, -1
    v_exp_f32 v127, v127
    v_exp_f32 v128, v128
    v_exp_f32 v129, v129
    v_exp_f32 v130, v130
    v_exp_f32 v131, v131
    s_setprio 2
    v_exp_f32 v132, v132
    v_exp_f32 v133, v133
    s_waitcnt lgkmcnt(2)
    v_smfmac_f32_32x32x32_bf16 v[36:51], v[96:99], v[124:131], v6
    s_mov_b64 exec, s[66:67]
    ds_read_b128 v[96:99], v5 offset:1536
    s_mov_b64 exec, -1
    v_exp_f32 v134, v134
    v_exp_f32 v135, v135
    v_exp_f32 v136, v136
    v_exp_f32 v137, v137
    s_waitcnt lgkmcnt(2)
    v_mfma_f32_32x32x16_bf16 v[116:131], v[88:91], v[84:87], v[100:115]
    ds_read_b128 v[88:91], v4 offset:3072
    v_exp_f32 v138, v138
    v_exp_f32 v139, v139
    v_exp_f32 v140, v140
    v_exp_f32 v141, v141
    v_exp_f32 v142, v142
    s_waitcnt lgkmcnt(2)
    v_smfmac_f32_32x32x32_bf16 v[36:51], v[92:95], v[132:139], v6
    s_mov_b64 exec, s[66:67]
    ds_read_b128 v[92:95], v5 offset:2048
    s_mov_b64 exec, -1
    v_exp_f32 v143, v143
    v_exp_f32 v144, v144
    v_exp_f32 v145, v145
    v_exp_f32 v146, v146
    v_exp_f32 v147, v147
    s_setprio 1
    v_exp_f32 v116, v116
    v_exp_f32 v117, v117
    s_waitcnt lgkmcnt(2)
    v_smfmac_f32_32x32x32_bf16 v[36:51], v[96:99], v[140:147], v6
    s_mov_b64 exec, s[66:67]
    ds_read_b128 v[96:99], v5 offset:2560
    s_mov_b64 exec, -1
    v_exp_f32 v118, v118
    v_exp_f32 v119, v119
    v_exp_f32 v120, v120
    v_exp_f32 v121, v121
    s_waitcnt lgkmcnt(2)
    v_mfma_f32_32x32x16_bf16 v[132:147], v[88:91], v[84:87], v[100:115]
    ds_read_b128 v[88:91], v4 offset:4096
    v_exp_f32 v122, v122
    v_exp_f32 v123, v123
    v_exp_f32 v124, v124
    v_exp_f32 v125, v125
    v_exp_f32 v126, v126
    s_waitcnt lgkmcnt(2)
    v_smfmac_f32_32x32x32_bf16 v[36:51], v[92:95], v[116:123], v6
    s_mov_b64 exec, s[66:67]
    ds_read_b128 v[92:95], v5 offset:3072
    s_mov_b64 exec, -1
    v_exp_f32 v127, v127
    v_exp_f32 v128, v128
    v_exp_f32 v129, v129
    v_exp_f32 v130, v130
    v_exp_f32 v131, v131
    s_setprio 0
    v_exp_f32 v132, v132
    v_exp_f32 v133, v133
    s_waitcnt lgkmcnt(2)
    v_smfmac_f32_32x32x32_bf16 v[36:51], v[96:99], v[124:131], v6
    s_mov_b64 exec, s[66:67]
    ds_read_b128 v[96:99], v5 offset:3584
    s_mov_b64 exec, -1
    v_exp_f32 v134, v134
    v_exp_f32 v135, v135
    v_exp_f32 v136, v136
    v_exp_f32 v137, v137
    s_waitcnt lgkmcnt(2)
    v_mfma_f32_32x32x16_bf16 v[116:131], v[88:91], v[84:87], v[100:115]
    ds_read_b128 v[88:91], v4 offset:5120
    v_exp_f32 v138, v138
    v_exp_f32 v139, v139
    v_exp_f32 v140, v140
    v_exp_f32 v141, v141
    v_exp_f32 v142, v142
    s_waitcnt lgkmcnt(2)
    v_smfmac_f32_32x32x32_bf16 v[36:51], v[92:95], v[132:139], v6
    s_mov_b64 exec, s[66:67]
    ds_read_b128 v[92:95], v5 offset:4096
    s_mov_b64 exec, -1
    v_exp_f32 v143, v143
    v_exp_f32 v144, v144
    v_exp_f32 v145, v145
    v_add_u32 v4, 4096, v4
    v_add_u32 v5, 4096, v5
    s_add_u32 s33, s33, 1
    s_cmp_lt_u32 s33, 16
    v_exp_f32 v146, v146
    v_exp_f32 v147, v147
    s_cbranch_scc1 AT_LOOP_12
M_TAIL:
    s_waitcnt lgkmcnt(0)
    s_setprio 3
    v_smfmac_f32_32x32x32_bf16 v[36:51], v[96:99], v[140:147], v6
    s_mov_b32 s29, 0x5d800000
    s_mov_b32 s30, 0x7b800000
    s_barrier
    s_nop 8
    v_max3_f32 v8, |v36|, |v37|, |v38|
    v_add_f32 v9, v36, v37
    v_add_f32 v10, v38, v39
    v_max3_f32 v8, v8, |v39|, |v40|
    v_add_f32 v9, v9, v40
    v_add_f32 v10, v10, v41
    v_max3_f32 v8, v8, |v41|, |v42|
    v_add_f32 v9, v9, v42
    v_add_f32 v10, v10, v43
    v_max_f32 v8, v8, |v43|
    v_add_f32 v9, v9, v10
    v_cmp_nlt_f32 vcc, v44, s29
    v_cmp_nlt_f32 s[68:69], v8, s30
    s_or_b64 vcc, vcc, s[68:69]
    v_cmp_u_f32 s[68:69], v9, v9
    s_or_b64 vcc, vcc, s[68:69]
    s_cbranch_vccz AT_DONE_14
    s_branch AT_nob_13F
AT_nob_13B:
    s_cmp_lg_u32 s33, 3
    s_cbranch_scc1 AT_nob_13X
    s_mov_b32 s56, 13
    s_barrier
    s_branch AT_nob_13
AT_nob_13X:
    buffer_load_dwordx4 v[12:15], v20, s[40:43], 0 offen
    buffer_load_dwordx4 v[16:19], v16, s[44:47], 0 offen
    s_branch AT_nob_13
AT_nob_13F:
    s_lshl_b32 s29, s27, 16
    s_add_u32 s29, s29, 2097152
    v_mov_b32 v8, 0xff800000
    s_mov_b32 s33, 0
AT_MAXLOOP_15:
    buffer_load_dwordx4 v[88:91], v3, s[36:39], s29 offen sc1
    s_add_u32 s29, s29, 1024
    s_waitcnt vmcnt(0)
    v_mfma_f32_32x32x16_bf16 v[116:131], v[88:91], v[84:87], 0
    s_nop 15
    v_max3_f32 v8, v8, v116, v117
    v_max3_f32 v8, v8, v118, v119
    v_max3_f32 v8, v8, v120, v121
    v_max3_f32 v8, v8, v122, v123
    v_max3_f32 v8, v8, v124, v125
    v_max3_f32 v8, v8, v126, v127
    v_max3_f32 v8, v8, v128, v129
    v_max3_f32 v8, v8, v130, v131
    s_add_u32 s33, s33, 1
    s_cmp_lt_u32 s33, 64
    s_cbranch_scc1 AT_MAXLOOP_15
    v_mov_b32 v9, v8
    v_subrev_u32 v5, 65536, v7
    s_sub_u32 s29, s29, 65536
    v_permlane32_swap_b32 v8, v9
    s_add_u32 s30, s29, 2097152
    s_mov_b32 s33, 0
    v_max_f32 v8, v8, v9
    v_sub_f32 v100, 0, v8
    v_mov_b32 v36, 0
    v_sub_f32 v101, 0, v8
    v_mov_b32 v37, 0
    v_sub_f32 v102, 0, v8
    v_mov_b32 v38, 0
    v_sub_f32 v103, 0, v8
    v_mov_b32 v39, 0
    v_sub_f32 v104, 0, v8
    v_mov_b32 v40, 0
    v_sub_f32 v105, 0, v8
    v_mov_b32 v41, 0
    v_sub_f32 v106, 0, v8
    v_mov_b32 v42, 0
    v_sub_f32 v107, 0, v8
    v_mov_b32 v43, 0
    v_sub_f32 v108, 0, v8
    v_mov_b32 v44, 0
    v_sub_f32 v109, 0, v8
    v_mov_b32 v45, 0
    v_sub_f32 v110, 0, v8
    v_mov_b32 v46, 0
    v_sub_f32 v111, 0, v8
    v_mov_b32 v47, 0
    v_sub_f32 v112, 0, v8
    v_mov_b32 v48, 0
    v_sub_f32 v113, 0, v8
    v_mov_b32 v49, 0
    v_sub_f32 v114, 0, v8
    v_mov_b32 v50, 0
    v_sub_f32 v115, 0, v8
    v_mov_b32 v51, 0
AT_REDO_16:
    buffer_load_dwordx4 v[88:91], v3, s[36:39], s29 offen sc1
    s_mov_b64 exec, s[66:67]
    buffer_load_dwordx4 v[92:95], v5, s[36:39], s30 offen sc1
    buffer_load_dwordx4 v[96:99], v5, s[36:39], s30 offen offset:512 sc1
    s_mov_b64 exec, -1
    s_add_u32 s29, s29, 1024
    s_add_u32 s30, s30, 1024
    s_waitcnt vmcnt(0)
    v_mfma_f32_32x32x16_bf16 v[116:131], v[88:91], v[84:87], v[100:115]
    s_nop 15
    v_exp_f32 v116, v116
    v_exp_f32 v117, v117
    v_exp_f32 v118, v118
    v_exp_f32 v119, v119
    v_exp_f32 v120, v120
    v_exp_f32 v121, v121
    v_exp_f32 v122, v122
    v_exp_f32 v123, v123
    v_exp_f32 v124, v124
    v_exp_f32 v125, v125
    v_exp_f32 v126, v126
    v_exp_f32 v127, v127
    v_exp_f32 v128, v128
    v_exp_f32 v129, v129
    v_exp_f32 v130, v130
    v_exp_f32 v131, v131
    s_nop 1
    v_smfmac_f32_32x32x32_bf16 v[36:51], v[92:95], v[116:123], v6
    v_smfmac_f32_32x32x32_bf16 v[36:51], v[96:99], v[124:131], v6
    s_add_u32 s33, s33, 1
    s_nop 15
    s_cmp_lt_u32 s33, 64
    s_cbranch_scc1 AT_REDO_16
AT_DONE_14:
    v_rcp_f32 v8, v44
    s_nop 0
    v_mul_f32 v36, v36, v8
    v_mul_f32 v37, v37, v8
    v_mul_f32 v38, v38, v8
    v_mul_f32 v39, v39, v8
    v_mul_f32 v40, v40, v8
    v_mul_f32 v41, v41, v8
    v_mul_f32 v42, v42, v8
    v_mul_f32 v43, v43, v8
    v_cvt_pk_bf16_f32 v88, v36, v37
    v_cvt_pk_bf16_f32 v89, v38, v39
    v_cvt_pk_bf16_f32 v90, v40, v41
    v_cvt_pk_bf16_f32 v91, v42, v43
    buffer_store_dwordx4 v[88:91], v3, s[36:39], s3 offen sc1
    s_mov_b32 s59, 255
    s_mov_b32 s33, 0
    s_mov_b64 s[68:69], -1
    v_xor_b32 v5, 64, v21
    s_barrier
    ds_read_b64_tr_b16 v[24:25], v21 offset:0
    ds_read_b64_tr_b16 v[26:27], v21 offset:1024
    ds_read_b64_tr_b16 v[28:29], v5 offset:0
    ds_read_b64_tr_b16 v[30:31], v5 offset:1024
    ds_read_b64_tr_b16 v[32:33], v21 offset:2048
    ds_read_b64_tr_b16 v[34:35], v21 offset:3072
    ds_read_b64_tr_b16 v[52:53], v5 offset:2048
    ds_read_b64_tr_b16 v[54:55], v5 offset:3072
    v_mov_b32 v84, 0
    v_mov_b32 v85, 0
    v_mov_b32 v86, 0
    v_mov_b32 v87, 0
    v_mov_b32 v88, 0
    v_mov_b32 v89, 0
    v_mov_b32 v90, 0
    v_mov_b32 v91, 0
    s_waitcnt lgkmcnt(6)
    ds_read_b64_tr_b16 v[56:57], v21 offset:4096
    ds_read_b64_tr_b16 v[58:59], v21 offset:5120
    ds_read_b64_tr_b16 v[60:61], v5 offset:4096
    ds_read_b64_tr_b16 v[62:63], v5 offset:5120
    ds_read_b64_tr_b16 v[64:65], v21 offset:6144
    ds_read_b64_tr_b16 v[66:67], v21 offset:7168
    ds_read_b64_tr_b16 v[68:69], v5 offset:6144
    ds_read_b64_tr_b16 v[70:71], v5 offset:7168
    v_mov_b32 v92, 0
    v_mov_b32 v93, 0
    v_mov_b32 v94, 0
    v_mov_b32 v95, 0
    v_mov_b32 v96, 0
    v_mov_b32 v97, 0
    v_mov_b32 v98, 0
    v_mov_b32 v99, 0
    s_waitcnt lgkmcnt(6)
    ds_read_b64_tr_b16 v[72:73], v21 offset:8192
    ds_read_b64_tr_b16 v[74:75], v21 offset:9216
    ds_read_b64_tr_b16 v[76:77], v5 offset:8192
    ds_read_b64_tr_b16 v[78:79], v5 offset:9216
    ds_read_b64_tr_b16 v[80:81], v21 offset:10240
    ds_read_b64_tr_b16 v[82:83], v21 offset:11264
    ds_read_b64_tr_b16 v[148:149], v5 offset:10240
    ds_read_b64_tr_b16 v[150:151], v5 offset:11264
    v_mov_b32 v100, 0
    v_mov_b32 v101, 0
    v_mov_b32 v102, 0
    v_mov_b32 v103, 0
    v_mov_b32 v104, 0
    v_mov_b32 v105, 0
    v_mov_b32 v106, 0
    v_mov_b32 v107, 0
    s_waitcnt lgkmcnt(6)
    ds_read_b64_tr_b16 v[152:153], v21 offset:12288
    ds_read_b64_tr_b16 v[154:155], v21 offset:13312
    ds_read_b64_tr_b16 v[156:157], v5 offset:12288
    ds_read_b64_tr_b16 v[158:159], v5 offset:13312
    ds_read_b64_tr_b16 v[160:161], v21 offset:14336
    ds_read_b64_tr_b16 v[162:163], v21 offset:15360
    ds_read_b64_tr_b16 v[164:165], v5 offset:14336
    ds_read_b64_tr_b16 v[166:167], v5 offset:15360
    v_mov_b32 v108, 0
    v_mov_b32 v109, 0
    v_mov_b32 v110, 0
    v_mov_b32 v111, 0
    v_mov_b32 v112, 0
    v_mov_b32 v113, 0
    v_mov_b32 v114, 0
    v_mov_b32 v115, 0
    s_waitcnt lgkmcnt(0)
    s_barrier
    s_waitcnt vmcnt(0)
    buffer_load_dwordx4 v[116:119], v3, s[36:39], s10 offen offset:0 sc1
    buffer_load_dwordx4 v[120:123], v3, s[36:39], s10 offen offset:1024 sc1
    buffer_load_dwordx4 v[124:127], v3, s[36:39], s10 offen offset:2048 sc1
    buffer_load_dwordx4 v[128:131], v3, s[36:39], s10 offen offset:3072 sc1
    buffer_load_dwordx4 v[132:135], v3, s[36:39], s11 offen offset:0 sc1
    buffer_load_dwordx4 v[136:139], v3, s[36:39], s11 offen offset:1024 sc1
    buffer_load_dwordx4 v[140:143], v3, s[36:39], s11 offen offset:2048 sc1
    buffer_load_dwordx4 v[144:147], v3, s[36:39], s11 offen offset:3072 sc1
    s_waitcnt vmcnt(7)
    v_max3_u32 v8, v116, v117, v118
    v_max_u32 v8, v8, v119
    v_cmp_eq_u32 vcc, -1, v8
    s_and_b64 vcc, vcc, s[68:69]
    s_cbranch_vccnz F_sk_21
    v_mfma_f32_32x32x16_bf16 v[84:99], v[24:27], v[116:119], v[84:99]
    v_mfma_f32_32x32x16_bf16 v[100:115], v[28:31], v[116:119], v[100:115]
    s_bitset0_b32 s59, 0
F_sk_21:
    s_waitcnt vmcnt(6)
    v_max3_u32 v9, v120, v121, v122
    v_max_u32 v9, v9, v123
    v_cmp_eq_u32 vcc, -1, v9
    s_and_b64 vcc, vcc, s[68:69]
    s_cbranch_vccnz F_sk_22
    v_mfma_f32_32x32x16_bf16 v[84:99], v[32:35], v[120:123], v[84:99]
    v_mfma_f32_32x32x16_bf16 v[100:115], v[52:55], v[120:123], v[100:115]
    s_bitset0_b32 s59, 1
F_sk_22:
    s_waitcnt vmcnt(5)
    v_max3_u32 v8, v124, v125, v126
    v_max_u32 v8, v8, v127
    v_cmp_eq_u32 vcc, -1, v8
    s_and_b64 vcc, vcc, s[68:69]
    s_cbranch_vccnz F_sk_23
    v_mfma_f32_32x32x16_bf16 v[84:99], v[56:59], v[124:127], v[84:99]
    v_mfma_f32_32x32x16_bf16 v[100:115], v[60:63], v[124:127], v[100:115]
    s_bitset0_b32 s59, 2
F_sk_23:
    s_waitcnt vmcnt(4)
    v_max3_u32 v9, v128, v129, v130
    v_max_u32 v9, v9, v131
    v_cmp_eq_u32 vcc, -1, v9
    s_and_b64 vcc, vcc, s[68:69]
    s_cbranch_vccnz F_sk_24
    v_mfma_f32_32x32x16_bf16 v[84:99], v[64:67], v[128:131], v[84:99]
    v_mfma_f32_32x32x16_bf16 v[100:115], v[68:71], v[128:131], v[100:115]
    s_bitset0_b32 s59, 3
F_sk_24:
    s_waitcnt vmcnt(3)
    v_max3_u32 v8, v132, v133, v134
    v_max_u32 v8, v8, v135
    v_cmp_eq_u32 vcc, -1, v8
    s_and_b64 vcc, vcc, s[68:69]
    s_cbranch_vccnz F_sk_25
    v_mfma_f32_32x32x16_bf16 v[84:99], v[72:75], v[132:135], v[84:99]
    v_mfma_f32_32x32x16_bf16 v[100:115], v[76:79], v[132:135], v[100:115]
    s_bitset0_b32 s59, 4
F_sk_25:
    s_waitcnt vmcnt(2)
    v_max3_u32 v9, v136, v137, v138
    v_max_u32 v9, v9, v139
    v_cmp_eq_u32 vcc, -1, v9
    s_and_b64 vcc, vcc, s[68:69]
    s_cbranch_vccnz F_sk_26
    v_mfma_f32_32x32x16_bf16 v[84:99], v[80:83], v[136:139], v[84:99]
    v_mfma_f32_32x32x16_bf16 v[100:115], v[148:151], v[136:139], v[100:115]
    s_bitset0_b32 s59, 5
F_sk_26:
    s_waitcnt vmcnt(1)
    v_max3_u32 v8, v140, v141, v142
    v_max_u32 v8, v8, v143
    v_cmp_eq_u32 vcc, -1, v8
    s_and_b64 vcc, vcc, s[68:69]
    s_cbranch_vccnz F_sk_27
    v_mfma_f32_32x32x16_bf16 v[84:99], v[152:155], v[140:143], v[84:99]
    v_mfma_f32_32x32x16_bf16 v[100:115], v[156:159], v[140:143], v[100:115]
    s_bitset0_b32 s59, 6
F_sk_27:
    s_waitcnt vmcnt(0)
    v_max3_u32 v9, v144, v145, v146
    v_max_u32 v9, v9, v147
    v_cmp_eq_u32 vcc, -1, v9
    s_and_b64 vcc, vcc, s[68:69]
    s_cbranch_vccnz F_sk_28
    v_mfma_f32_32x32x16_bf16 v[84:99], v[160:163], v[144:147], v[84:99]
    v_mfma_f32_32x32x16_bf16 v[100:115], v[164:167], v[144:147], v[100:115]
    s_bitset0_b32 s59, 7
F_sk_28:
    s_branch F_PH2_18
F_SLOW_17:
    s_and_b32 s29, s60, 15
    s_cbranch_scc0 F_skh_29
    s_bitcmp1_b32 s60, 0
    s_cbranch_scc0 F_sk_30
    buffer_load_dwordx4 v[116:119], v3, s[36:39], s10 offen offset:0 sc1
F_sk_30:
    s_bitcmp1_b32 s60, 1
    s_cbranch_scc0 F_sk_31
    buffer_load_dwordx4 v[120:123], v3, s[36:39], s10 offen offset:1024 sc1
F_sk_31:
    s_bitcmp1_b32 s60, 2
    s_cbranch_scc0 F_sk_32
    buffer_load_dwordx4 v[124:127], v3, s[36:39], s10 offen offset:2048 sc1
F_sk_32:
    s_bitcmp1_b32 s60, 3
    s_cbranch_scc0 F_sk_33
    buffer_load_dwordx4 v[128:131], v3, s[36:39], s10 offen offset:3072 sc1
F_sk_33:
F_skh_29:
    s_and_b32 s29, s60, 240
    s_cbranch_scc0 F_skh_34
    s_bitcmp1_b32 s60, 4
    s_cbranch_scc0 F_sk_35
    buffer_load_dwordx4 v[132:135], v3, s[36:39], s11 offen offset:0 sc1
F_sk_35:
    s_bitcmp1_b32 s60, 5
    s_cbranch_scc0 F_sk_36
    buffer_load_dwordx4 v[136:139], v3, s[36:39], s11 offen offset:1024 sc1
F_sk_36:
    s_bitcmp1_b32 s60, 6
    s_cbranch_scc0 F_sk_37
    buffer_load_dwordx4 v[140:143], v3, s[36:39], s11 offen offset:2048 sc1
F_sk_37:
    s_bitcmp1_b32 s60, 7
    s_cbranch_scc0 F_sk_38
    buffer_load_dwordx4 v[144:147], v3, s[36:39], s11 offen offset:3072 sc1
F_sk_38:
F_skh_34:
F_PH2B_19:
    s_waitcnt vmcnt(0)
    s_and_b32 s29, s60, 15
    s_cbranch_scc0 F_skh_39
    s_bitcmp1_b32 s60, 0
    s_cbranch_scc0 F_sk_40
    v_max3_u32 v8, v116, v117, v118
    v_max_u32 v8, v8, v119
    v_cmp_eq_u32 vcc, -1, v8
    s_and_b64 vcc, vcc, s[68:69]
    s_cbranch_vccnz F_sk_40
    v_mfma_f32_32x32x16_bf16 v[84:99], v[24:27], v[116:119], v[84:99]
    v_mfma_f32_32x32x16_bf16 v[100:115], v[28:31], v[116:119], v[100:115]
    s_bitset0_b32 s59, 0
F_sk_40:
    s_bitcmp1_b32 s60, 1
    s_cbranch_scc0 F_sk_41
    v_max3_u32 v9, v120, v121, v122
    v_max_u32 v9, v9, v123
    v_cmp_eq_u32 vcc, -1, v9
    s_and_b64 vcc, vcc, s[68:69]
    s_cbranch_vccnz F_sk_41
    v_mfma_f32_32x32x16_bf16 v[84:99], v[32:35], v[120:123], v[84:99]
    v_mfma_f32_32x32x16_bf16 v[100:115], v[52:55], v[120:123], v[100:115]
    s_bitset0_b32 s59, 1
F_sk_41:
    s_bitcmp1_b32 s60, 2
    s_cbranch_scc0 F_sk_42
    v_max3_u32 v8, v124, v125, v126
    v_max_u32 v8, v8, v127
    v_cmp_eq_u32 vcc, -1, v8
    s_and_b64 vcc, vcc, s[68:69]
    s_cbranch_vccnz F_sk_42
    v_mfma_f32_32x32x16_bf16 v[84:99], v[56:59], v[124:127], v[84:99]
    v_mfma_f32_32x32x16_bf16 v[100:115], v[60:63], v[124:127], v[100:115]
    s_bitset0_b32 s59, 2
F_sk_42:
    s_bitcmp1_b32 s60, 3
    s_cbranch_scc0 F_sk_43
    v_max3_u32 v9, v128, v129, v130
    v_max_u32 v9, v9, v131
    v_cmp_eq_u32 vcc, -1, v9
    s_and_b64 vcc, vcc, s[68:69]
    s_cbranch_vccnz F_sk_43
    v_mfma_f32_32x32x16_bf16 v[84:99], v[64:67], v[128:131], v[84:99]
    v_mfma_f32_32x32x16_bf16 v[100:115], v[68:71], v[128:131], v[100:115]
    s_bitset0_b32 s59, 3
F_sk_43:
F_skh_39:
    s_and_b32 s29, s60, 240
    s_cbranch_scc0 F_skh_44
    s_bitcmp1_b32 s60, 4
    s_cbranch_scc0 F_sk_45
    v_max3_u32 v8, v132, v133, v134
    v_max_u32 v8, v8, v135
    v_cmp_eq_u32 vcc, -1, v8
    s_and_b64 vcc, vcc, s[68:69]
    s_cbranch_vccnz F_sk_45
    v_mfma_f32_32x32x16_bf16 v[84:99], v[72:75], v[132:135], v[84:99]
    v_mfma_f32_32x32x16_bf16 v[100:115], v[76:79], v[132:135], v[100:115]
    s_bitset0_b32 s59, 4
F_sk_45:
    s_bitcmp1_b32 s60, 5
    s_cbranch_scc0 F_sk_46
    v_max3_u32 v9, v136, v137, v138
    v_max_u32 v9, v9, v139
    v_cmp_eq_u32 vcc, -1, v9
    s_and_b64 vcc, vcc, s[68:69]
    s_cbranch_vccnz F_sk_46
    v_mfma_f32_32x32x16_bf16 v[84:99], v[80:83], v[136:139], v[84:99]
    v_mfma_f32_32x32x16_bf16 v[100:115], v[148:151], v[136:139], v[100:115]
    s_bitset0_b32 s59, 5
F_sk_46:
    s_bitcmp1_b32 s60, 6
    s_cbranch_scc0 F_sk_47
    v_max3_u32 v8, v140, v141, v142
    v_max_u32 v8, v8, v143
    v_cmp_eq_u32 vcc, -1, v8
    s_and_b64 vcc, vcc, s[68:69]
    s_cbranch_vccnz F_sk_47
    v_mfma_f32_32x32x16_bf16 v[84:99], v[152:155], v[140:143], v[84:99]
    v_mfma_f32_32x32x16_bf16 v[100:115], v[156:159], v[140:143], v[100:115]
    s_bitset0_b32 s59, 6
F_sk_47:
    s_bitcmp1_b32 s60, 7
    s_cbranch_scc0 F_sk_48
    v_max3_u32 v9, v144, v145, v146
    v_max_u32 v9, v9, v147
    v_cmp_eq_u32 vcc, -1, v9
    s_and_b64 vcc, vcc, s[68:69]
    s_cbranch_vccnz F_sk_48
    v_mfma_f32_32x32x16_bf16 v[84:99], v[160:163], v[144:147], v[84:99]
    v_mfma_f32_32x32x16_bf16 v[100:115], v[164:167], v[144:147], v[100:115]
    s_bitset0_b32 s59, 7
F_sk_48:
F_skh_44:
F_PH2_18:
    s_cmp_eq_u32 s59, 0
    s_cbranch_scc1 F_DONE_20
    s_mov_b32 s60, s59
    s_add_u32 s33, s33, 1
    s_bcnt1_i32_b32 s29, s59
    s_cmp_le_u32 s29, 8
    s_cbranch_scc1 F_GO_50S
    s_mov_b64 exec, 255
F_PL_49:
    s_sleep 6
    buffer_load_dword v10, v1, s[36:39], s10 offen sc1
    s_add_u32 s33, s33, 1
    s_waitcnt vmcnt(0)
    v_cmp_eq_u32 vcc, -1, v10
    s_and_b32 s29, vcc_lo, s59
    s_cbranch_scc0 F_GO_50
    s_cmp_lt_u32 s33, 0x8000
    s_cbranch_scc1 F_PL_49
    s_branch F_GO_50
F_GO_50S:
    s_sleep 6
F_GO_50:
    s_mov_b64 exec, -1
    s_cmp_lt_u32 s33, 0x8000
    s_cselect_b64 s[68:69], -1, 0
    s_and_b32 s29, s60, 15
    s_cbranch_scc0 F_skh_51
    s_bitcmp1_b32 s60, 0
    s_cbranch_scc0 F_sk_52
    buffer_load_dwordx4 v[116:119], v3, s[36:39], s10 offen offset:0 sc1
F_sk_52:
    s_bitcmp1_b32 s60, 1
    s_cbranch_scc0 F_sk_53
    buffer_load_dwordx4 v[120:123], v3, s[36:39], s10 offen offset:1024 sc1
F_sk_53:
    s_bitcmp1_b32 s60, 2
    s_cbranch_scc0 F_sk_54
    buffer_load_dwordx4 v[124:127], v3, s[36:39], s10 offen offset:2048 sc1
F_sk_54:
    s_bitcmp1_b32 s60, 3
    s_cbranch_scc0 F_sk_55
    buffer_load_dwordx4 v[128:131], v3, s[36:39], s10 offen offset:3072 sc1
F_sk_55:
F_skh_51:
    s_and_b32 s29, s60, 240
    s_cbranch_scc0 F_skh_56
    s_bitcmp1_b32 s60, 4
    s_cbranch_scc0 F_sk_57
    buffer_load_dwordx4 v[132:135], v3, s[36:39], s11 offen offset:0 sc1
F_sk_57:
    s_bitcmp1_b32 s60, 5
    s_cbranch_scc0 F_sk_58
    buffer_load_dwordx4 v[136:139], v3, s[36:39], s11 offen offset:1024 sc1
F_sk_58:
    s_bitcmp1_b32 s60, 6
    s_cbranch_scc0 F_sk_59
    buffer_load_dwordx4 v[140:143], v3, s[36:39], s11 offen offset:2048 sc1
F_sk_59:
    s_bitcmp1_b32 s60, 7
    s_cbranch_scc0 F_sk_60
    buffer_load_dwordx4 v[144:147], v3, s[36:39], s11 offen offset:3072 sc1
F_sk_60:
F_skh_56:
    s_branch F_PH2B_19
F_DONE_20:
    s_nop 3
    v_lshlrev_b32 v52, 16, v12
    v_and_b32 v53, 0xffff0000, v12
    v_lshlrev_b32 v54, 16, v13
    v_and_b32 v55, 0xffff0000, v13
    v_lshlrev_b32 v56, 16, v14
    v_and_b32 v57, 0xffff0000, v14
    v_lshlrev_b32 v58, 16, v15
    v_and_b32 v59, 0xffff0000, v15
    v_lshlrev_b32 v60, 16, v16
    v_and_b32 v61, 0xffff0000, v16
    v_lshlrev_b32 v62, 16, v17
    v_and_b32 v63, 0xffff0000, v17
    v_lshlrev_b32 v64, 16, v18
    v_and_b32 v65, 0xffff0000, v18
    v_lshlrev_b32 v66, 16, v19
    v_and_b32 v67, 0xffff0000, v19
    v_xor_b32 v8, 0, v22
    ds_write_b128 v8, v[84:87]
    v_xor_b32 v9, 32, v22
    ds_write_b128 v9, v[88:91]
    v_xor_b32 v8, 64, v22
    ds_write_b128 v8, v[92:95]
    v_xor_b32 v9, 96, v22
    ds_write_b128 v9, v[96:99]
    v_xor_b32 v8, 128, v22
    ds_write_b128 v8, v[100:103]
    v_xor_b32 v9, 160, v22
    ds_write_b128 v9, v[104:107]
    v_xor_b32 v8, 192, v22
    ds_write_b128 v8, v[108:111]
    v_xor_b32 v9, 224, v22
    ds_write_b128 v9, v[112:115]
    v_add_f32 v52, v52, v60
    v_add_f32 v53, v53, v61
    v_add_f32 v54, v54, v62
    v_add_f32 v55, v55, v63
    v_add_f32 v56, v56, v64
    v_add_f32 v57, v57, v65
    v_add_f32 v58, v58, v66
    v_add_f32 v59, v59, v67
    v_xor_b32 v9, 16, v23
    v_add_u32 v7, 131072, v23
    v_add_u32 v8, 131072, v9
    s_waitcnt lgkmcnt(0)
    s_barrier
    ds_read_b128 v[116:119], v23 offset:0
    ds_read_b128 v[120:123], v9 offset:0
    ds_read_b128 v[124:127], v23 offset:16384
    ds_read_b128 v[128:131], v9 offset:16384
    ds_read_b128 v[132:135], v23 offset:40960
    ds_read_b128 v[136:139], v9 offset:40960
    ds_read_b128 v[140:143], v7 offset:0
    ds_read_b128 v[144:147], v8 offset:0
    ds_read_b128 v[84:87], v7 offset:16384
    ds_read_b128 v[88:91], v8 offset:16384
    s_waitcnt lgkmcnt(6)
    v_add_f32 v52, v52, v116
    v_add_f32 v53, v53, v117
    v_add_f32 v54, v54, v118
    v_add_f32 v55, v55, v119
    v_add_f32 v56, v56, v120
    v_add_f32 v57, v57, v121
    v_add_f32 v58, v58, v122
    v_add_f32 v59, v59, v123
    v_add_f32 v52, v52, v124
    v_add_f32 v53, v53, v125
    v_add_f32 v54, v54, v126
    v_add_f32 v55, v55, v127
    v_add_f32 v56, v56, v128
    v_add_f32 v57, v57, v129
    v_add_f32 v58, v58, v130
    v_add_f32 v59, v59, v131
    s_waitcnt lgkmcnt(2)
    v_add_f32 v132, v132, v140
    v_add_f32 v133, v133, v141
    v_add_f32 v134, v134, v142
    v_add_f32 v135, v135, v143
    v_add_f32 v136, v136, v144
    v_add_f32 v137, v137, v145
    v_add_f32 v138, v138, v146
    v_add_f32 v139, v139, v147
    v_add_f32 v52, v52, v132
    v_add_f32 v53, v53, v133
    v_add_f32 v54, v54, v134
    v_add_f32 v55, v55, v135
    v_add_f32 v56, v56, v136
    v_add_f32 v57, v57, v137
    v_add_f32 v58, v58, v138
    v_add_f32 v59, v59, v139
    s_waitcnt lgkmcnt(0)
    v_add_f32 v52, v52, v84
    v_add_f32 v53, v53, v85
    v_add_f32 v54, v54, v86
    v_add_f32 v55, v55, v87
    v_add_f32 v56, v56, v88
    v_add_f32 v57, v57, v89
    v_add_f32 v58, v58, v90
    v_add_f32 v59, v59, v91
    v_cvt_pk_bf16_f32 v116, v52, v53
    v_cvt_pk_bf16_f32 v117, v54, v55
    v_cvt_pk_bf16_f32 v118, v56, v57
    v_cvt_pk_bf16_f32 v119, v58, v59
    buffer_store_dwordx4 v[116:119], v20, s[48:51], 0 offen
    s_endpgm
AUX_2:
    s_setprio 1
    s_sub_u32 s56, s24, 8
    v_lshlrev_b32 v3, 4, v2
    v_lshrrev_b32 v4, 3, v2
    v_bfe_u32 v5, v2, 4, 1
    v_lshlrev_b32 v5, 2, v5
    v_and_b32 v6, 7, v2
    v_xor_b32 v5, v5, v6
    v_lshlrev_b32 v5, 4, v5
    v_mul_u32_u24 v6, 3072, v4
    v_add_u32 v10, v6, v5
    v_add_u32 v11, 23552, v10
    v_mul_u32_u24 v6, 2752, v4
    v_add_u32 v12, v6, v5
    v_add_u32 v13, 20992, v12
    s_lshl_b32 s57, s26, 7
    s_lshl_b32 s29, s56, 10
    s_add_u32 s57, s57, s29
    s_mul_i32 s58, s26, 384
    s_lshl_b32 s29, s56, 7
    s_add_u32 s59, s58, s29
    s_lshl_b32 s60, s56, 13
    s_add_u32 s60, s60, 65536
    s_and_b32 s63, s25, 7
    s_mov_b32 s42, 1572864
    s_mov_b32 s43, 0x00020000
    s_mov_b32 s46, 1409024
    s_mov_b32 s47, 0x00020000
    s_cmp_eq_u32 s26, 7
    s_cselect_b32 s29, 0, 1409024
    s_cmp_eq_u32 s56, 0
    s_cselect_b32 s50, 1409024, s29
    s_mov_b32 s61, s29
    s_mov_b32 s51, 0x00020000
    s_waitcnt lgkmcnt(0)
    s_mov_b32 s40, s6
    s_mov_b32 s41, s7
    s_mov_b32 s44, s12
    s_mov_b32 s45, s13
    s_mov_b32 s48, s12
    s_mov_b32 s49, s13
    s_lshl_b32 s64, s27, 3
    s_add_u32 s64, s64, s28
    s_lshl_b32 s64, s64, 8
    s_add_u32 s64, s64, 14024704
    s_lshl_b32 s65, s25, 3
    s_add_u32 s65, s65, s26
    s_lshl_b32 s65, s65, 8
    s_add_u32 s65, s65, 14090240
    s_cmp_lg_u32 s2, 0
    s_cbranch_scc1 X_nonce_61
    s_cmp_lg_u32 s56, 3
    s_cbranch_scc1 X_nonce_61
    v_mov_b32 v8, 0
    s_mov_b32 s29, 14221312
    s_mov_b64 exec, 1
    buffer_load_dwordx2 v[16:17], v8, s[36:39], s29 offen sc1
    s_waitcnt vmcnt(0)
    v_add_co_u32 v16, vcc, 1, v16
    s_nop 1
    v_addc_co_u32 v17, vcc, 0, v17, vcc
    v_max_u32 v16, 1, v16
    buffer_store_dwordx2 v[16:17], v8, s[36:39], s29 offen sc1
    global_store_dwordx2 v8, v[16:17], s[22:23] sc1
    s_mov_b64 exec, -1
X_nonce_61:
    v_lshrrev_b32 v4, 5, v2
    v_bfe_u32 v5, v2, 2, 2
    v_lshl_add_u32 v5, v4, 2, v5
    v_lshlrev_b32 v5, 7, v5
    v_bfe_u32 v4, v2, 3, 1
    v_lshl_add_u32 v5, v4, 6, v5
    v_bfe_u32 v4, v2, 4, 1
    v_lshl_add_u32 v5, v4, 5, v5
    v_and_b32 v4, 3, v2
    v_lshl_add_u32 v5, v4, 3, v5
    s_lshl_b32 s29, s56, 13
    s_add_u32 s29, s29, 131072
    v_add_u32 v140, s29, v5
    v_xor_b32 v141, 64, v140
    v_lshrrev_b32 v8, 3, v2
    v_bfe_u32 v5, v2, 4, 1
    v_lshlrev_b32 v5, 2, v5
    v_and_b32 v6, 7, v2
    v_xor_b32 v5, v5, v6
    v_lshlrev_b32 v5, 4, v5
    v_lshl_add_u32 v142, v8, 10, v5
    v_add_u32 v143, 7168, v142
    v_and_b32 v144, 31, v2
    v_lshlrev_b32 v144, 3, v144
    v_mov_b32 v20, 0
    v_mov_b32 v21, 0
    v_mov_b32 v22, 0
    v_mov_b32 v23, 0
    v_mov_b32 v24, 0
    v_mov_b32 v25, 0
    v_mov_b32 v26, 0
    v_mov_b32 v27, 0
    v_mov_b32 v28, 0
    v_mov_b32 v29, 0
    v_mov_b32 v30, 0
    v_mov_b32 v31, 0
    v_mov_b32 v32, 0
    v_mov_b32 v33, 0
    v_mov_b32 v34, 0
    v_mov_b32 v35, 0
    v_mov_b32 v36, 0
    v_mov_b32 v37, 0
    v_mov_b32 v38, 0
    v_mov_b32 v39, 0
    v_mov_b32 v40, 0
    v_mov_b32 v41, 0
    v_mov_b32 v42, 0
    v_mov_b32 v43, 0
    v_mov_b32 v44, 0
    v_mov_b32 v45, 0
    v_mov_b32 v46, 0
    v_mov_b32 v47, 0
    v_mov_b32 v48, 0
    v_mov_b32 v49, 0
    v_mov_b32 v50, 0
    v_mov_b32 v51, 0
    v_mov_b32 v52, 0
    v_mov_b32 v53, 0
    v_mov_b32 v54, 0
    v_mov_b32 v55, 0
    v_mov_b32 v56, 0
    v_mov_b32 v57, 0
    v_mov_b32 v58, 0
    v_mov_b32 v59, 0
    v_mov_b32 v60, 0
    v_mov_b32 v61, 0
    v_mov_b32 v62, 0
    v_mov_b32 v63, 0
    v_mov_b32 v64, 0
    v_mov_b32 v65, 0
    v_mov_b32 v66, 0
    v_mov_b32 v67, 0
    v_mov_b32 v68, 0
    v_mov_b32 v69, 0
    v_mov_b32 v70, 0
    v_mov_b32 v71, 0
    v_mov_b32 v72, 0
    v_mov_b32 v73, 0
    v_mov_b32 v74, 0
    v_mov_b32 v75, 0
    v_mov_b32 v76, 0
    v_mov_b32 v77, 0
    v_mov_b32 v78, 0
    v_mov_b32 v79, 0
    v_mov_b32 v80, 0
    v_mov_b32 v81, 0
    v_mov_b32 v82, 0
    v_mov_b32 v83, 0
    s_and_b32 s66, s25, 7
    s_barrier
    s_cmp_eq_u32 s56, 3
    s_cbranch_scc1 X_W11_62
    s_add_u32 s32, s66, 0
    s_and_b32 s32, s32, 7
    s_mul_i32 s32, s32, 196608
    s_add_u32 s32, s32, s57
    s_add_u32 m0, s60, 0
    s_add_u32 s33, s32, 0
    buffer_load_dwordx4 v10, s[40:43], s33 offen lds
    buffer_load_dwordx4 v11, s[40:43], s33 offen offset:1024 lds
    s_add_u32 m0, s60, 2048
    s_add_u32 s33, s32, 49152
    buffer_load_dwordx4 v10, s[40:43], s33 offen lds
    buffer_load_dwordx4 v11, s[40:43], s33 offen offset:1024 lds
    s_add_u32 m0, s60, 4096
    s_add_u32 s33, s32, 98304
    buffer_load_dwordx4 v10, s[40:43], s33 offen lds
    buffer_load_dwordx4 v11, s[40:43], s33 offen offset:1024 lds
    s_add_u32 m0, s60, 6144
    s_add_u32 s33, s32, 147456
    buffer_load_dwordx4 v10, s[40:43], s33 offen lds
    buffer_load_dwordx4 v11, s[40:43], s33 offen offset:1024 lds
    s_add_u32 s32, s66, 1
    s_and_b32 s32, s32, 7
    s_mul_i32 s32, s32, 196608
    s_add_u32 s32, s32, s57
    s_add_u32 m0, s60, 24576
    s_add_u32 s33, s32, 0
    buffer_load_dwordx4 v10, s[40:43], s33 offen lds
    buffer_load_dwordx4 v11, s[40:43], s33 offen offset:1024 lds
    s_add_u32 m0, s60, 26624
    s_add_u32 s33, s32, 49152
    buffer_load_dwordx4 v10, s[40:43], s33 offen lds
    buffer_load_dwordx4 v11, s[40:43], s33 offen offset:1024 lds
    s_add_u32 m0, s60, 28672
    s_add_u32 s33, s32, 98304
    buffer_load_dwordx4 v10, s[40:43], s33 offen lds
    buffer_load_dwordx4 v11, s[40:43], s33 offen offset:1024 lds
    s_add_u32 m0, s60, 30720
    s_add_u32 s33, s32, 147456
    buffer_load_dwordx4 v10, s[40:43], s33 offen lds
    buffer_load_dwordx4 v11, s[40:43], s33 offen offset:1024 lds
    s_waitcnt vmcnt(8)
    s_barrier
    s_add_u32 s32, s66, 2
    s_and_b32 s32, s32, 7
    s_mul_i32 s32, s32, 196608
    s_add_u32 s32, s32, s57
    s_add_u32 m0, s60, 49152
    s_add_u32 s33, s32, 0
    buffer_load_dwordx4 v10, s[40:43], s33 offen lds
    buffer_load_dwordx4 v11, s[40:43], s33 offen offset:1024 lds
    s_add_u32 m0, s60, 51200
    s_add_u32 s33, s32, 49152
    buffer_load_dwordx4 v10, s[40:43], s33 offen lds
    buffer_load_dwordx4 v11, s[40:43], s33 offen offset:1024 lds
    s_add_u32 m0, s60, 53248
    s_add_u32 s33, s32, 98304
    buffer_load_dwordx4 v10, s[40:43], s33 offen lds
    buffer_load_dwordx4 v11, s[40:43], s33 offen offset:1024 lds
    s_add_u32 m0, s60, 55296
    s_add_u32 s33, s32, 147456
    buffer_load_dwordx4 v10, s[40:43], s33 offen lds
    buffer_load_dwordx4 v11, s[40:43], s33 offen offset:1024 lds
    s_add_u32 s32, s66, 3
    s_and_b32 s32, s32, 7
    s_mul_i32 s32, s32, 196608
    s_add_u32 s32, s32, s57
    s_add_u32 m0, s60, 73728
    s_add_u32 s33, s32, 0
    buffer_load_dwordx4 v10, s[40:43], s33 offen lds
    buffer_load_dwordx4 v11, s[40:43], s33 offen offset:1024 lds
    s_add_u32 m0, s60, 75776
    s_add_u32 s33, s32, 49152
    buffer_load_dwordx4 v10, s[40:43], s33 offen lds
    buffer_load_dwordx4 v11, s[40:43], s33 offen offset:1024 lds
    s_add_u32 m0, s60, 77824
    s_add_u32 s33, s32, 98304
    buffer_load_dwordx4 v10, s[40:43], s33 offen lds
    buffer_load_dwordx4 v11, s[40:43], s33 offen offset:1024 lds
    s_add_u32 m0, s60, 79872
    s_add_u32 s33, s32, 147456
    buffer_load_dwordx4 v10, s[40:43], s33 offen lds
    buffer_load_dwordx4 v11, s[40:43], s33 offen offset:1024 lds
    s_waitcnt vmcnt(16)
    s_barrier
    s_add_u32 s32, s66, 4
    s_and_b32 s32, s32, 7
    s_mul_i32 s32, s32, 196608
    s_add_u32 s32, s32, s57
    s_add_u32 m0, s60, 0
    s_add_u32 s33, s32, 0
    buffer_load_dwordx4 v10, s[40:43], s33 offen lds
    buffer_load_dwordx4 v11, s[40:43], s33 offen offset:1024 lds
    s_add_u32 m0, s60, 2048
    s_add_u32 s33, s32, 49152
    buffer_load_dwordx4 v10, s[40:43], s33 offen lds
    buffer_load_dwordx4 v11, s[40:43], s33 offen offset:1024 lds
    s_add_u32 m0, s60, 4096
    s_add_u32 s33, s32, 98304
    buffer_load_dwordx4 v10, s[40:43], s33 offen lds
    buffer_load_dwordx4 v11, s[40:43], s33 offen offset:1024 lds
    s_add_u32 m0, s60, 6144
    s_add_u32 s33, s32, 147456
    buffer_load_dwordx4 v10, s[40:43], s33 offen lds
    buffer_load_dwordx4 v11, s[40:43], s33 offen offset:1024 lds
    s_waitcnt vmcnt(16)
    s_barrier
    s_add_u32 s32, s66, 5
    s_and_b32 s32, s32, 7
    s_mul_i32 s32, s32, 196608
    s_add_u32 s32, s32, s57
    s_add_u32 m0, s60, 24576
    s_add_u32 s33, s32, 0
    buffer_load_dwordx4 v10, s[40:43], s33 offen lds
    buffer_load_dwordx4 v11, s[40:43], s33 offen offset:1024 lds
    s_add_u32 m0, s60, 26624
    s_add_u32 s33, s32, 49152
    buffer_load_dwordx4 v10, s[40:43], s33 offen lds
    buffer_load_dwordx4 v11, s[40:43], s33 offen offset:1024 lds
    s_add_u32 m0, s60, 28672
    s_add_u32 s33, s32, 98304
    buffer_load_dwordx4 v10, s[40:43], s33 offen lds
    buffer_load_dwordx4 v11, s[40:43], s33 offen offset:1024 lds
    s_add_u32 m0, s60, 30720
    s_add_u32 s33, s32, 147456
    buffer_load_dwordx4 v10, s[40:43], s33 offen lds
    buffer_load_dwordx4 v11, s[40:43], s33 offen offset:1024 lds
    s_waitcnt vmcnt(16)
    s_barrier
    s_add_u32 s32, s66, 6
    s_and_b32 s32, s32, 7
    s_mul_i32 s32, s32, 196608
    s_add_u32 s32, s32, s57
    s_add_u32 m0, s60, 49152
    s_add_u32 s33, s32, 0
    buffer_load_dwordx4 v10, s[40:43], s33 offen lds
    buffer_load_dwordx4 v11, s[40:43], s33 offen offset:1024 lds
    s_add_u32 m0, s60, 51200
    s_add_u32 s33, s32, 49152
    buffer_load_dwordx4 v10, s[40:43], s33 offen lds
    buffer_load_dwordx4 v11, s[40:43], s33 offen offset:1024 lds
    s_add_u32 m0, s60, 53248
    s_add_u32 s33, s32, 98304
    buffer_load_dwordx4 v10, s[40:43], s33 offen lds
    buffer_load_dwordx4 v11, s[40:43], s33 offen offset:1024 lds
    s_add_u32 m0, s60, 55296
    s_add_u32 s33, s32, 147456
    buffer_load_dwordx4 v10, s[40:43], s33 offen lds
    buffer_load_dwordx4 v11, s[40:43], s33 offen offset:1024 lds
    s_waitcnt vmcnt(16)
    s_barrier
    s_add_u32 s32, s66, 7
    s_and_b32 s32, s32, 7
    s_mul_i32 s32, s32, 196608
    s_add_u32 s32, s32, s57
    s_add_u32 m0, s60, 73728
    s_add_u32 s33, s32, 0
    buffer_load_dwordx4 v10, s[40:43], s33 offen lds
    buffer_load_dwordx4 v11, s[40:43], s33 offen offset:1024 lds
    s_add_u32 m0, s60, 75776
    s_add_u32 s33, s32, 49152
    buffer_load_dwordx4 v10, s[40:43], s33 offen lds
    buffer_load_dwordx4 v11, s[40:43], s33 offen offset:1024 lds
    s_add_u32 m0, s60, 77824
    s_add_u32 s33, s32, 98304
    buffer_load_dwordx4 v10, s[40:43], s33 offen lds
    buffer_load_dwordx4 v11, s[40:43], s33 offen offset:1024 lds
    s_add_u32 m0, s60, 79872
    s_add_u32 s33, s32, 147456
    buffer_load_dwordx4 v10, s[40:43], s33 offen lds
    buffer_load_dwordx4 v11, s[40:43], s33 offen offset:1024 lds
    s_waitcnt vmcnt(16)
    s_barrier
    s_add_u32 s32, s66, 0
    s_and_b32 s32, s32, 7
    s_mul_i32 s32, s32, 176128
    s_add_u32 s32, s32, s59
    s_add_u32 m0, s60, 0
    s_add_u32 s33, s32, 0
    buffer_load_dwordx4 v12, s[48:51], s33 offen lds
    buffer_load_dwordx4 v13, s[48:51], s33 offen offset:1024 lds
    s_add_u32 m0, s60, 2048
    s_add_u32 s33, s32, 44032
    buffer_load_dwordx4 v12, s[48:51], s33 offen lds
    buffer_load_dwordx4 v13, s[48:51], s33 offen offset:1024 lds
    s_add_u32 m0, s60, 4096
    s_add_u32 s33, s32, 88064
    buffer_load_dwordx4 v12, s[48:51], s33 offen lds
    buffer_load_dwordx4 v13, s[48:51], s33 offen offset:1024 lds
    s_add_u32 m0, s60, 6144
    s_add_u32 s33, s32, 132096
    buffer_load_dwordx4 v12, s[48:51], s33 offen lds
    buffer_load_dwordx4 v13, s[48:51], s33 offen offset:1024 lds
    s_waitcnt vmcnt(16)
    s_barrier
    s_add_u32 s32, s66, 1
    s_and_b32 s32, s32, 7
    s_mul_i32 s32, s32, 176128
    s_add_u32 s32, s32, s59
    s_add_u32 m0, s60, 24576
    s_add_u32 s33, s32, 0
    buffer_load_dwordx4 v12, s[48:51], s33 offen lds
    buffer_load_dwordx4 v13, s[48:51], s33 offen offset:1024 lds
    s_add_u32 m0, s60, 26624
    s_add_u32 s33, s32, 44032
    buffer_load_dwordx4 v12, s[48:51], s33 offen lds
    buffer_load_dwordx4 v13, s[48:51], s33 offen offset:1024 lds
    s_add_u32 m0, s60, 28672
    s_add_u32 s33, s32, 88064
    buffer_load_dwordx4 v12, s[48:51], s33 offen lds
    buffer_load_dwordx4 v13, s[48:51], s33 offen offset:1024 lds
    s_add_u32 m0, s60, 30720
    s_add_u32 s33, s32, 132096
    buffer_load_dwordx4 v12, s[48:51], s33 offen lds
    buffer_load_dwordx4 v13, s[48:51], s33 offen offset:1024 lds
    s_waitcnt vmcnt(16)
    s_barrier
    s_add_u32 s32, s66, 2
    s_and_b32 s32, s32, 7
    s_mul_i32 s32, s32, 176128
    s_add_u32 s32, s32, s59
    s_add_u32 m0, s60, 49152
    s_add_u32 s33, s32, 0
    buffer_load_dwordx4 v12, s[48:51], s33 offen lds
    buffer_load_dwordx4 v13, s[48:51], s33 offen offset:1024 lds
    s_add_u32 m0, s60, 51200
    s_add_u32 s33, s32, 44032
    buffer_load_dwordx4 v12, s[48:51], s33 offen lds
    buffer_load_dwordx4 v13, s[48:51], s33 offen offset:1024 lds
    s_add_u32 m0, s60, 53248
    s_add_u32 s33, s32, 88064
    buffer_load_dwordx4 v12, s[48:51], s33 offen lds
    buffer_load_dwordx4 v13, s[48:51], s33 offen offset:1024 lds
    s_add_u32 m0, s60, 55296
    s_add_u32 s33, s32, 132096
    buffer_load_dwordx4 v12, s[48:51], s33 offen lds
    buffer_load_dwordx4 v13, s[48:51], s33 offen offset:1024 lds
    s_waitcnt vmcnt(16)
    s_barrier
    s_add_u32 s32, s66, 3
    s_and_b32 s32, s32, 7
    s_mul_i32 s32, s32, 176128
    s_add_u32 s32, s32, s59
    s_add_u32 m0, s60, 73728
    s_add_u32 s33, s32, 0
    buffer_load_dwordx4 v12, s[48:51], s33 offen lds
    buffer_load_dwordx4 v13, s[48:51], s33 offen offset:1024 lds
    s_add_u32 m0, s60, 75776
    s_add_u32 s33, s32, 44032
    buffer_load_dwordx4 v12, s[48:51], s33 offen lds
    buffer_load_dwordx4 v13, s[48:51], s33 offen offset:1024 lds
    s_add_u32 m0, s60, 77824
    s_add_u32 s33, s32, 88064
    buffer_load_dwordx4 v12, s[48:51], s33 offen lds
    buffer_load_dwordx4 v13, s[48:51], s33 offen offset:1024 lds
    s_add_u32 m0, s60, 79872
    s_add_u32 s33, s32, 132096
    buffer_load_dwordx4 v12, s[48:51], s33 offen lds
    buffer_load_dwordx4 v13, s[48:51], s33 offen offset:1024 lds
    s_waitcnt vmcnt(16)
    s_barrier
    s_add_u32 s32, s66, 4
    s_and_b32 s32, s32, 7
    s_mul_i32 s32, s32, 176128
    s_add_u32 s32, s32, s59
    s_add_u32 m0, s60, 0
    s_add_u32 s33, s32, 0
    buffer_load_dwordx4 v12, s[48:51], s33 offen lds
    buffer_load_dwordx4 v13, s[48:51], s33 offen offset:1024 lds
    s_add_u32 m0, s60, 2048
    s_add_u32 s33, s32, 44032
    buffer_load_dwordx4 v12, s[48:51], s33 offen lds
    buffer_load_dwordx4 v13, s[48:51], s33 offen offset:1024 lds
    s_add_u32 m0, s60, 4096
    s_add_u32 s33, s32, 88064
    buffer_load_dwordx4 v12, s[48:51], s33 offen lds
    buffer_load_dwordx4 v13, s[48:51], s33 offen offset:1024 lds
    s_add_u32 m0, s60, 6144
    s_add_u32 s33, s32, 132096
    buffer_load_dwordx4 v12, s[48:51], s33 offen lds
    buffer_load_dwordx4 v13, s[48:51], s33 offen offset:1024 lds
    s_waitcnt vmcnt(16)
    s_barrier
    s_add_u32 s32, s66, 5
    s_and_b32 s32, s32, 7
    s_mul_i32 s32, s32, 176128
    s_add_u32 s32, s32, s59
    s_add_u32 m0, s60, 24576
    s_add_u32 s33, s32, 0
    buffer_load_dwordx4 v12, s[48:51], s33 offen lds
    buffer_load_dwordx4 v13, s[48:51], s33 offen offset:1024 lds
    s_add_u32 m0, s60, 26624
    s_add_u32 s33, s32, 44032
    buffer_load_dwordx4 v12, s[48:51], s33 offen lds
    buffer_load_dwordx4 v13, s[48:51], s33 offen offset:1024 lds
    s_add_u32 m0, s60, 28672
    s_add_u32 s33, s32, 88064
    buffer_load_dwordx4 v12, s[48:51], s33 offen lds
    buffer_load_dwordx4 v13, s[48:51], s33 offen offset:1024 lds
    s_add_u32 m0, s60, 30720
    s_add_u32 s33, s32, 132096
    buffer_load_dwordx4 v12, s[48:51], s33 offen lds
    buffer_load_dwordx4 v13, s[48:51], s33 offen offset:1024 lds
    s_load_dwordx2 s[68:69], s[22:23], 0
    s_waitcnt vmcnt(16)
    s_barrier
    s_add_u32 s32, s66, 6
    s_and_b32 s32, s32, 7
    s_mul_i32 s32, s32, 176128
    s_add_u32 s32, s32, s59
    s_add_u32 m0, s60, 49152
    s_add_u32 s33, s32, 0
    buffer_load_dwordx4 v12, s[48:51], s33 offen lds
    buffer_load_dwordx4 v13, s[48:51], s33 offen offset:1024 lds
    s_add_u32 m0, s60, 51200
    s_add_u32 s33, s32, 44032
    buffer_load_dwordx4 v12, s[48:51], s33 offen lds
    buffer_load_dwordx4 v13, s[48:51], s33 offen offset:1024 lds
    s_add_u32 m0, s60, 53248
    s_add_u32 s33, s32, 88064
    buffer_load_dwordx4 v12, s[48:51], s33 offen lds
    buffer_load_dwordx4 v13, s[48:51], s33 offen offset:1024 lds
    s_add_u32 m0, s60, 55296
    s_add_u32 s33, s32, 132096
    buffer_load_dwordx4 v12, s[48:51], s33 offen lds
    buffer_load_dwordx4 v13, s[48:51], s33 offen offset:1024 lds
    s_waitcnt vmcnt(16)
    s_barrier
    s_add_u32 s32, s66, 7
    s_and_b32 s32, s32, 7
    s_mul_i32 s32, s32, 176128
    s_add_u32 s32, s32, s59
    s_add_u32 m0, s60, 73728
    s_add_u32 s33, s32, 0
    buffer_load_dwordx4 v12, s[48:51], s33 offen lds
    buffer_load_dwordx4 v13, s[48:51], s33 offen offset:1024 lds
    s_add_u32 m0, s60, 75776
    s_add_u32 s33, s32, 44032
    buffer_load_dwordx4 v12, s[48:51], s33 offen lds
    buffer_load_dwordx4 v13, s[48:51], s33 offen offset:1024 lds
    s_add_u32 m0, s60, 77824
    s_add_u32 s33, s32, 88064
    buffer_load_dwordx4 v12, s[48:51], s33 offen lds
    buffer_load_dwordx4 v13, s[48:51], s33 offen offset:1024 lds
    s_add_u32 m0, s60, 79872
    s_add_u32 s33, s32, 132096
    buffer_load_dwordx4 v12, s[48:51], s33 offen lds
    buffer_load_dwordx4 v13, s[48:51], s33 offen offset:1024 lds
    s_waitcnt vmcnt(16)
    s_barrier
    s_waitcnt vmcnt(8)
    s_barrier
    s_waitcnt vmcnt(0)
    s_barrier
    s_branch X_WJ_63
X_W11_62:
    s_barrier
    s_barrier
    s_barrier
    s_barrier
    s_barrier
    s_barrier
    s_barrier
    s_barrier
    s_barrier
    s_barrier
    s_barrier
    s_load_dwordx2 s[68:69], s[22:23], 0
    s_barrier
    s_barrier
    s_barrier
    s_barrier
    s_barrier
X_WJ_63:
    s_waitcnt lgkmcnt(0)
    s_cmp_lg_u32 s68, 0
    s_cbranch_scc1 X_tok_64
    s_mov_b32 s33, 0
    v_mov_b32 v8, 0
X_tokl_65:
    global_load_dwordx2 v[16:17], v8, s[22:23] sc1
    s_add_u32 s33, s33, 1
    s_waitcnt vmcnt(0)
    v_readfirstlane_b32 s68, v16
    v_readfirstlane_b32 s69, v17
    s_cmp_lg_u32 s68, 0
    s_cbranch_scc1 X_tok_64
    s_sleep 2
    s_cmp_lt_u32 s33, 0x20000
    s_cbranch_scc1 X_tokl_65
X_tok_64:
    s_lshl_b32 s57, s27, 16
    s_lshl_b32 s59, s28, 13
    s_add_u32 s59, s59, s57
    s_lshl_b32 s60, s56, 11
    s_add_u32 s59, s59, s60
    s_add_u32 s59, s59, 0
    s_add_u32 s57, s57, 2097152
    s_lshl_b32 s31, s56, 3
    s_lshl_b32 s58, 255, s31
    s_lshl_b32 s31, s28, 2
    s_add_u32 s31, s31, s56
    s_lshl_b32 s61, 1, s31
    s_lshl_b32 s62, s56, 12
    buffer_load_dwordx2 v[16:17], v144, s[36:39], s64 offen sc1
    s_barrier
    s_mov_b32 s33, 0
    s_branch X_qc_67
X_ql_66:
    s_sleep 2
    buffer_load_dwordx2 v[16:17], v144, s[36:39], s64 offen sc1
X_qc_67:
    s_add_u32 s33, s33, 1
    s_waitcnt vmcnt(0)
    v_cmp_eq_u64 vcc, s[68:69], v[16:17]
    s_cmp_ge_u32 s33, 0x20000
    s_cselect_b32 s29, -1, vcc_lo
    s_and_b32 s30, s29, s61
    s_cbranch_scc0 X_ql_66
    s_and_b32 s29, s29, s58
    s_bcnt1_i32_b32 s30, s29
    s_cmp_lt_u32 s30, 2
    s_cbranch_scc1 X_ql_66
    s_add_u32 m0, s60, 131072
    s_nop 0
    buffer_load_dwordx4 v3, s[36:39], s59 offen sc1 lds
    buffer_load_dwordx4 v3, s[36:39], s59 offen offset:1024 sc1 lds
    s_ff1_i32_b32 s31, s29
    s_bitset0_b32 s29, s31
    s_bitset0_b32 s58, s31
    s_lshl_b32 s31, s31, 11
    s_add_u32 s31, s31, s57
    s_mov_b32 m0, s62
    s_add_u32 s32, s31, 2097152
    buffer_load_dwordx4 v3, s[36:39], s31 offen sc1 lds
    buffer_load_dwordx4 v3, s[36:39], s31 offen offset:1024 sc1 lds
    s_add_u32 m0, s62, 65536
    s_add_u32 s62, s62, 2048
    buffer_load_dwordx4 v3, s[36:39], s32 offen sc1 lds
    buffer_load_dwordx4 v3, s[36:39], s32 offen offset:1024 sc1 lds
    s_ff1_i32_b32 s31, s29
    s_bitset0_b32 s29, s31
    s_bitset0_b32 s58, s31
    s_lshl_b32 s31, s31, 11
    s_add_u32 s31, s31, s57
    s_mov_b32 m0, s62
    s_add_u32 s32, s31, 2097152
    buffer_load_dwordx4 v3, s[36:39], s31 offen sc1 lds
    buffer_load_dwordx4 v3, s[36:39], s31 offen offset:1024 sc1 lds
    s_add_u32 m0, s62, 65536
    s_add_u32 s62, s62, 2048
    buffer_load_dwordx4 v3, s[36:39], s32 offen sc1 lds
    buffer_load_dwordx4 v3, s[36:39], s32 offen offset:1024 sc1 lds
    s_mul_i32 s66, s56, 24576
    s_mul_i32 s67, s56, 393216
    s_lshl_b32 s31, s26, 7
    s_add_u32 s67, s67, s31
    s_lshl_b32 s59, s56, 13
    s_add_u32 s59, s59, 131072
    s_cmp_eq_u32 s56, 3
    s_cselect_b32 s60, 4, 6
    s_waitcnt vmcnt(0)
    s_barrier
    s_mul_i32 s62, s56, 12288
    s_add_u32 s62, s62, 16384
    s_mov_b32 s33, 0
X_q2_69:
    v_cmp_ne_u64 vcc, s[68:69], v[16:17]
    s_and_b32 s29, vcc_lo, s58
    s_cbranch_scc0 X_q2g_70
    s_sleep 2
    buffer_load_dwordx2 v[16:17], v144, s[36:39], s64 offen sc1
    s_add_u32 s33, s33, 1
    s_waitcnt vmcnt(0)
    s_cmp_lt_u32 s33, 0x20000
    s_cbranch_scc1 X_q2_69
X_q2g_70:
    s_mov_b32 s29, s58
X_q2t_71:
    s_ff1_i32_b32 s31, s29
    s_bitset0_b32 s29, s31
    s_bitset0_b32 s58, s31
    s_lshl_b32 s31, s31, 11
    s_add_u32 s31, s31, s57
    s_mov_b32 m0, s62
    s_add_u32 s32, s31, 2097152
    buffer_load_dwordx4 v3, s[36:39], s31 offen sc1 lds
    buffer_load_dwordx4 v3, s[36:39], s31 offen offset:1024 sc1 lds
    s_add_u32 m0, s62, 65536
    s_add_u32 s62, s62, 2048
    buffer_load_dwordx4 v3, s[36:39], s32 offen sc1 lds
    buffer_load_dwordx4 v3, s[36:39], s32 offen offset:1024 sc1 lds
    s_cmp_lg_u32 s29, 0
    s_cbranch_scc1 X_q2t_71
    s_lshl_b32 s29, s28, 3
    s_lshl_b32 s30, s56, 1
    s_add_u32 s29, s29, s30
    s_mul_i32 s29, s29, 120832
    s_lshl_b32 s30, s27, 10
    s_add_u32 s29, s29, s30
    s_add_u32 s61, s29, 6291456
    s_add_u32 s62, s61, 120832
    v_mov_b32 v16, -1
    v_mov_b32 v17, -1
    v_mov_b32 v18, -1
    v_mov_b32 v19, -1
    buffer_store_dwordx4 v[16:19], v3, s[36:39], s61 offen sc1
    buffer_store_dwordx4 v[16:19], v3, s[36:39], s62 offen sc1
    s_mul_i32 s30, s25, 241664
    s_add_u32 s30, s30, 6324224
    s_add_u32 s48, s36, s30
    s_addc_u32 s49, s37, 0
    s_mov_b32 s50, 88064
    s_add_u32 s52, s48, 120832
    s_addc_u32 s53, s49, 0
    s_mov_b32 s54, 88064
    s_mov_b32 s55, 0x00020000
    s_and_b32 s29, s56, 1
    s_mul_i32 s30, s29, 12288
    s_lshr_b32 s31, s56, 1
    s_mul_i32 s31, s31, 6144
    s_add_u32 s30, s30, s31
    s_add_u32 s30, s30, 139264
    v_add_u32 v4, s30, v3
    ds_read_b128 v[116:119], v4 offset:0
    ds_read_b128 v[120:123], v4 offset:1024
    ds_read_b128 v[124:127], v4 offset:2048
    ds_read_b128 v[128:131], v4 offset:3072
    ds_read_b128 v[132:135], v4 offset:4096
    ds_read_b128 v[136:139], v4 offset:5120
    s_mul_i32 s30, s26, 12288
    s_add_u32 s31, s31, s30
    s_mul_i32 s30, s29, 120832
    s_add_u32 s44, s48, s30
    s_addc_u32 s45, s49, 0
    s_mov_b32 s46, 88064
    s_add_u32 s30, s31, 4096
    s_waitcnt lgkmcnt(0)
    s_mov_b32 s29, s30
    s_mov_b32 s32, s31
    buffer_store_dwordx4 v[116:119], v3, s[44:47], s32 offen offset:0 sc1
    buffer_store_dwordx4 v[120:123], v3, s[44:47], s32 offen offset:1024 sc1
    buffer_store_dwordx4 v[124:127], v3, s[44:47], s32 offen offset:2048 sc1
    buffer_store_dwordx4 v[128:131], v3, s[44:47], s32 offen offset:3072 sc1
    buffer_store_dwordx4 v[132:135], v3, s[44:47], s29 offen offset:0 sc1
    buffer_store_dwordx4 v[136:139], v3, s[44:47], s29 offen offset:1024 sc1
    s_mov_b32 s40, s16
    s_mov_b32 s41, s17
    s_mov_b32 s42, 1409024
    s_mul_i32 s29, s63, 172
    s_mul_i32 s30, s56, 43
    s_add_u32 s29, s29, s30
    v_min_u32 v4, 42, v2
    v_add_u32 v4, s29, v4
    v_lshlrev_b32 v4, 10, v4
    s_lshl_b32 s30, s26, 7
    buffer_load_dword v7, v4, s[40:43], s30 offen
    s_waitcnt vmcnt(7)
    s_barrier
    s_waitcnt vmcnt(1)
    s_lshl_b32 s32, s26, 2
    s_add_u32 s32, s32, s56
    s_lshl_b32 s29, s25, 11
    s_lshl_b32 s30, s32, 3
    s_add_u32 s29, s29, s30
    s_add_u32 s29, s29, 14090240
    v_lshlrev_b32 v4, 8, v2
    v_mov_b64 v[18:19], s[68:69]
    s_mov_b64 exec, 255
    buffer_store_dwordx2 v[18:19], v4, s[36:39], s29 offen sc1
    s_mov_b64 exec, -1
X_noflag_72:
    s_cmp_lg_u32 s56, 0
    s_cbranch_scc1 X_noflag_73
    s_lshl_b32 s29, s28, 13
    s_lshl_b32 s30, s27, 3
    s_add_u32 s29, s29, s30
    s_add_u32 s29, s29, 14155776
    v_lshlrev_b32 v4, 8, v2
    v_mov_b64 v[18:19], s[68:69]
    s_mov_b64 exec, 255
    s_mov_b32 exec_lo, -1
    buffer_store_dwordx2 v[18:19], v4, s[36:39], s29 offen sc1
    s_mov_b64 exec, -1
X_noflag_73:
    s_mov_b32 s33, 0
    s_mov_b64 exec, 255
    s_mov_b32 exec_lo, -1
X_poll_74:
    buffer_load_dwordx2 v[16:17], v144, s[36:39], s65 offen sc1
    s_add_u32 s33, s33, 1
    s_waitcnt vmcnt(0)
    v_cmp_ne_u64 vcc, s[68:69], v[16:17]
    s_cbranch_vccz X_polld_75
    s_sleep 2
    s_cmp_lt_u32 s33, 0x20000
    s_cbranch_scc1 X_poll_74
X_polld_75:
    s_mov_b64 exec, -1
    s_add_u32 m0, s59, 0
    buffer_load_dwordx4 v[84:87], v3, s[48:51], s66 offen sc1
    buffer_load_dwordx4 v[88:91], v3, s[52:55], s66 offen sc1
    buffer_load_dwordx4 v142, s[40:43], s67 offen lds
    buffer_load_dwordx4 v143, s[40:43], s67 offen offset:1024 lds
    s_add_u32 s66, s66, 1024
    s_add_u32 s67, s67, 16384
    s_add_u32 m0, s59, 2048
    buffer_load_dwordx4 v[92:95], v3, s[48:51], s66 offen sc1
    buffer_load_dwordx4 v[96:99], v3, s[52:55], s66 offen sc1
    buffer_load_dwordx4 v142, s[40:43], s67 offen lds
    buffer_load_dwordx4 v143, s[40:43], s67 offen offset:1024 lds
    s_add_u32 s66, s66, 1024
    s_add_u32 s67, s67, 16384
    s_add_u32 m0, s59, 4096
    buffer_load_dwordx4 v[100:103], v3, s[48:51], s66 offen sc1
    buffer_load_dwordx4 v[104:107], v3, s[52:55], s66 offen sc1
    buffer_load_dwordx4 v142, s[40:43], s67 offen lds
    buffer_load_dwordx4 v143, s[40:43], s67 offen offset:1024 lds
    s_add_u32 s66, s66, 1024
    s_add_u32 s67, s67, 16384
    s_mov_b32 s33, 0
X_FFN2_76:
    s_waitcnt vmcnt(8)
    ds_read_b64_tr_b16 v[116:117], v140 offset:0
    ds_read_b64_tr_b16 v[118:119], v140 offset:1024
    ds_read_b64_tr_b16 v[120:121], v141 offset:0
    ds_read_b64_tr_b16 v[122:123], v141 offset:1024
    s_add_u32 m0, s59, 6144
    buffer_load_dwordx4 v[108:111], v3, s[48:51], s66 offen sc1
    buffer_load_dwordx4 v[112:115], v3, s[52:55], s66 offen sc1
    buffer_load_dwordx4 v142, s[40:43], s67 offen lds
    buffer_load_dwordx4 v143, s[40:43], s67 offen offset:1024 lds
    s_add_u32 s66, s66, 1024
    s_add_u32 s67, s67, 16384
    s_waitcnt lgkmcnt(0)
    v_mfma_f32_32x32x16_bf16 v[20:35], v[116:119], v[84:87], v[20:35]
    s_sleep 1
    v_mfma_f32_32x32x16_bf16 v[36:51], v[120:123], v[84:87], v[36:51]
    s_sleep 1
    v_mfma_f32_32x32x16_bf16 v[52:67], v[116:119], v[88:91], v[52:67]
    s_sleep 1
    v_mfma_f32_32x32x16_bf16 v[68:83], v[120:123], v[88:91], v[68:83]
    s_waitcnt vmcnt(8)
    ds_read_b64_tr_b16 v[124:125], v140 offset:2048
    ds_read_b64_tr_b16 v[126:127], v140 offset:3072
    ds_read_b64_tr_b16 v[128:129], v141 offset:2048
    ds_read_b64_tr_b16 v[130:131], v141 offset:3072
    s_add_u32 m0, s59, 0
    buffer_load_dwordx4 v[84:87], v3, s[48:51], s66 offen sc1
    buffer_load_dwordx4 v[88:91], v3, s[52:55], s66 offen sc1
    buffer_load_dwordx4 v142, s[40:43], s67 offen lds
    buffer_load_dwordx4 v143, s[40:43], s67 offen offset:1024 lds
    s_add_u32 s66, s66, 1024
    s_add_u32 s67, s67, 16384
    s_waitcnt lgkmcnt(0)
    v_mfma_f32_32x32x16_bf16 v[20:35], v[124:127], v[92:95], v[20:35]
    s_sleep 1
    v_mfma_f32_32x32x16_bf16 v[36:51], v[128:131], v[92:95], v[36:51]
    s_sleep 1
    v_mfma_f32_32x32x16_bf16 v[52:67], v[124:127], v[96:99], v[52:67]
    s_sleep 1
    v_mfma_f32_32x32x16_bf16 v[68:83], v[128:131], v[96:99], v[68:83]
    s_waitcnt vmcnt(8)
    ds_read_b64_tr_b16 v[116:117], v140 offset:4096
    ds_read_b64_tr_b16 v[118:119], v140 offset:5120
    ds_read_b64_tr_b16 v[120:121], v141 offset:4096
    ds_read_b64_tr_b16 v[122:123], v141 offset:5120
    s_add_u32 m0, s59, 2048
    buffer_load_dwordx4 v[92:95], v3, s[48:51], s66 offen sc1
    buffer_load_dwordx4 v[96:99], v3, s[52:55], s66 offen sc1
    buffer_load_dwordx4 v142, s[40:43], s67 offen lds
    buffer_load_dwordx4 v143, s[40:43], s67 offen offset:1024 lds
    s_add_u32 s66, s66, 1024
    s_add_u32 s67, s67, 16384
    s_waitcnt lgkmcnt(0)
    v_mfma_f32_32x32x16_bf16 v[20:35], v[116:119], v[100:103], v[20:35]
    s_sleep 1
    v_mfma_f32_32x32x16_bf16 v[36:51], v[120:123], v[100:103], v[36:51]
    s_sleep 1
    v_mfma_f32_32x32x16_bf16 v[52:67], v[116:119], v[104:107], v[52:67]
    s_sleep 1
    v_mfma_f32_32x32x16_bf16 v[68:83], v[120:123], v[104:107], v[68:83]
    s_waitcnt vmcnt(8)
    ds_read_b64_tr_b16 v[124:125], v140 offset:6144
    ds_read_b64_tr_b16 v[126:127], v140 offset:7168
    ds_read_b64_tr_b16 v[128:129], v141 offset:6144
    ds_read_b64_tr_b16 v[130:131], v141 offset:7168
    s_add_u32 m0, s59, 4096
    buffer_load_dwordx4 v[100:103], v3, s[48:51], s66 offen sc1
    buffer_load_dwordx4 v[104:107], v3, s[52:55], s66 offen sc1
    buffer_load_dwordx4 v142, s[40:43], s67 offen lds
    buffer_load_dwordx4 v143, s[40:43], s67 offen offset:1024 lds
    s_add_u32 s66, s66, 1024
    s_add_u32 s67, s67, 16384
    s_waitcnt lgkmcnt(0)
    v_mfma_f32_32x32x16_bf16 v[20:35], v[124:127], v[108:111], v[20:35]
    s_sleep 1
    v_mfma_f32_32x32x16_bf16 v[36:51], v[128:131], v[108:111], v[36:51]
    s_sleep 1
    v_mfma_f32_32x32x16_bf16 v[52:67], v[124:127], v[112:115], v[52:67]
    s_sleep 1
    v_mfma_f32_32x32x16_bf16 v[68:83], v[128:131], v[112:115], v[68:83]
    s_add_u32 s33, s33, 1
    s_cmp_lt_u32 s33, s60
    s_cbranch_scc1 X_FFN2_76
    s_getpc_b64 s[10:11]
X_here:
    s_add_u32 s10, s10, M_TAIL-X_here
    s_addc_u32 s11, s11, -1
    v_lshlrev_b32 v4, 7, v2
    s_mov_b64 exec, 268435455
    global_load_dword v5, v4, s[10:11]
    s_mov_b64 exec, -1
    s_add_u32 s29, s65, 65536
    s_mov_b32 s33, 0
    s_mov_b64 exec, 255
    s_mov_b32 exec_lo, -1
X_poll_77:
    buffer_load_dwordx2 v[16:17], v144, s[36:39], s29 offen sc1
    s_add_u32 s33, s33, 1
    s_waitcnt vmcnt(0)
    v_cmp_ne_u64 vcc, s[68:69], v[16:17]
    s_cbranch_vccz X_polld_78
    s_sleep 2
    s_cmp_lt_u32 s33, 0x20000
    s_cbranch_scc1 X_poll_77
X_polld_78:
    s_mov_b64 exec, -1
    s_lshl_b32 s30, s56, 14
    s_add_u32 s31, s30, 49152
    s_cmp_eq_u32 s56, 0
    s_cselect_b32 s31, 40960, s31
    v_and_b32 v4, 31, v2
    v_lshrrev_b32 v6, 5, v2
    v_and_b32 v7, 15, v2
    v_xor_b32 v6, v6, v7
    v_lshlrev_b32 v6, 4, v6
    v_lshl_add_u32 v4, v4, 8, v6
    v_add_u32 v4, s31, v4
    s_mov_b32 s44, s8
    s_mov_b32 s45, s9
    s_mov_b32 s46, 524288
    s_lshl_b32 s29, s56, 16
    s_lshl_b32 s31, s26, 7
    s_add_u32 s29, s29, s31
    s_lshl_b32 s30, s56, 13
    v_add_u32 v5, s30, v3
    s_add_u32 m0, s59, 0
    s_add_u32 s31, s29, 0
    buffer_load_dwordx4 v142, s[44:47], s31 offen lds
    buffer_load_dwordx4 v143, s[44:47], s31 offen offset:1024 lds
    s_add_u32 s31, s31, 262144
    buffer_load_dwordx4 v[84:87], v142, s[44:47], s31 offen
    buffer_load_dwordx4 v[88:91], v143, s[44:47], s31 offen offset:1024
    s_add_u32 m0, s59, 2048
    s_add_u32 s31, s29, 16384
    buffer_load_dwordx4 v142, s[44:47], s31 offen lds
    buffer_load_dwordx4 v143, s[44:47], s31 offen offset:1024 lds
    s_add_u32 s31, s31, 262144
    buffer_load_dwordx4 v[92:95], v142, s[44:47], s31 offen
    buffer_load_dwordx4 v[96:99], v143, s[44:47], s31 offen offset:1024
    s_add_u32 m0, s59, 4096
    s_add_u32 s31, s29, 32768
    buffer_load_dwordx4 v142, s[44:47], s31 offen lds
    buffer_load_dwordx4 v143, s[44:47], s31 offen offset:1024 lds
    s_add_u32 s31, s31, 262144
    buffer_load_dwordx4 v[100:103], v142, s[44:47], s31 offen
    buffer_load_dwordx4 v[104:107], v143, s[44:47], s31 offen offset:1024
    s_add_u32 m0, s59, 6144
    s_add_u32 s31, s29, 49152
    buffer_load_dwordx4 v142, s[44:47], s31 offen lds
    buffer_load_dwordx4 v143, s[44:47], s31 offen offset:1024 lds
    s_add_u32 s31, s31, 262144
    buffer_load_dwordx4 v[108:111], v142, s[44:47], s31 offen
    buffer_load_dwordx4 v[112:115], v143, s[44:47], s31 offen offset:1024
    s_waitcnt vmcnt(0)
    v_mov_b32 v8, 32768
    v_mov_b32 v9, 0
    s_setprio 3
    s_barrier
    ds_write_b32 v8, v9
    ds_write_b128 v5, v[84:87] offset:0
    ds_write_b128 v5, v[88:91] offset:1024
    ds_write_b128 v5, v[92:95] offset:2048
    ds_write_b128 v5, v[96:99] offset:3072
    ds_write_b128 v5, v[100:103] offset:4096
    ds_write_b128 v5, v[104:107] offset:5120
    ds_write_b128 v5, v[108:111] offset:6144
    ds_write_b128 v5, v[112:115] offset:7168
    s_waitcnt lgkmcnt(0)
    s_barrier
    s_setprio 1
    s_barrier
    v_xor_b32 v6, 0, v4
    ds_write_b128 v6, v[20:23] offset:0
    ds_write_b128 v6, v[52:55] offset:8192
    v_xor_b32 v7, 32, v4
    ds_write_b128 v7, v[24:27] offset:0
    ds_write_b128 v7, v[56:59] offset:8192
    v_xor_b32 v6, 64, v4
    ds_write_b128 v6, v[28:31] offset:0
    ds_write_b128 v6, v[60:63] offset:8192
    v_xor_b32 v7, 96, v4
    ds_write_b128 v7, v[32:35] offset:0
    ds_write_b128 v7, v[64:67] offset:8192
    v_xor_b32 v6, 128, v4
    ds_write_b128 v6, v[36:39] offset:0
    ds_write_b128 v6, v[68:71] offset:8192
    v_xor_b32 v7, 160, v4
    ds_write_b128 v7, v[40:43] offset:0
    ds_write_b128 v7, v[72:75] offset:8192
    v_xor_b32 v6, 192, v4
    ds_write_b128 v6, v[44:47] offset:0
    ds_write_b128 v6, v[76:79] offset:8192
    v_xor_b32 v7, 224, v4
    ds_write_b128 v7, v[48:51] offset:0
    ds_write_b128 v7, v[80:83] offset:8192
    v_lshrrev_b32 v4, 2, v2
    v_and_b32 v5, 3, v2
    v_lshlrev_b32 v5, 2, v5
    v_xor_b32 v5, v5, v4
    v_lshlrev_b32 v5, 4, v5
    v_lshl_add_u32 v4, v4, 8, v5
    s_lshl_b32 s30, s56, 12
    s_add_u32 s30, s30, 40960
    v_add_u32 v4, s30, v4
    v_xor_b32 v5, 16, v4
    v_xor_b32 v6, 32, v4
    v_xor_b32 v7, 48, v4
    s_waitcnt lgkmcnt(0)
    v_mov_b32 v9, 1
    s_mov_b64 exec, 1
    ds_add_u32 v8, v9
X_sp_79:
    ds_read_b32 v9, v8
    s_waitcnt lgkmcnt(0)
    v_cmp_ne_u32 vcc, 4, v9
    s_cbranch_vccnz X_sp_79
    s_mov_b64 exec, -1
    ds_read_b128 v[20:23], v4 offset:0
    ds_read_b128 v[24:27], v5 offset:0
    ds_read_b128 v[28:31], v6 offset:0
    ds_read_b128 v[32:35], v7 offset:0
    ds_read_b128 v[36:39], v4 offset:24576
    ds_read_b128 v[40:43], v5 offset:24576
    ds_read_b128 v[44:47], v6 offset:24576
    ds_read_b128 v[48:51], v7 offset:24576
    ds_read_b128 v[52:55], v4 offset:40960
    ds_read_b128 v[56:59], v5 offset:40960
    ds_read_b128 v[60:63], v6 offset:40960
    ds_read_b128 v[64:67], v7 offset:40960
    s_waitcnt lgkmcnt(4)
    ds_read_b128 v[68:71], v4 offset:57344
    ds_read_b128 v[72:75], v5 offset:57344
    ds_read_b128 v[76:79], v6 offset:57344
    ds_read_b128 v[80:83], v7 offset:57344
    v_add_f32 v20, v20, v36
    v_add_f32 v21, v21, v37
    v_add_f32 v22, v22, v38
    v_add_f32 v23, v23, v39
    v_add_f32 v24, v24, v40
    v_add_f32 v25, v25, v41
    v_add_f32 v26, v26, v42
    v_add_f32 v27, v27, v43
    v_add_f32 v28, v28, v44
    v_add_f32 v29, v29, v45
    v_add_f32 v30, v30, v46
    v_add_f32 v31, v31, v47
    v_add_f32 v32, v32, v48
    v_add_f32 v33, v33, v49
    v_add_f32 v34, v34, v50
    v_add_f32 v35, v35, v51
    s_waitcnt lgkmcnt(0)
    v_add_f32 v52, v52, v68
    v_add_f32 v53, v53, v69
    v_add_f32 v54, v54, v70
    v_add_f32 v55, v55, v71
    v_add_f32 v56, v56, v72
    v_add_f32 v57, v57, v73
    v_add_f32 v58, v58, v74
    v_add_f32 v59, v59, v75
    v_add_f32 v60, v60, v76
    v_add_f32 v61, v61, v77
    v_add_f32 v62, v62, v78
    v_add_f32 v63, v63, v79
    v_add_f32 v64, v64, v80
    v_add_f32 v65, v65, v81
    v_add_f32 v66, v66, v82
    v_add_f32 v67, v67, v83
    v_add_f32 v20, v20, v52
    v_add_f32 v21, v21, v53
    v_add_f32 v22, v22, v54
    v_add_f32 v23, v23, v55
    v_add_f32 v24, v24, v56
    v_add_f32 v25, v25, v57
    v_add_f32 v26, v26, v58
    v_add_f32 v27, v27, v59
    v_add_f32 v28, v28, v60
    v_add_f32 v29, v29, v61
    v_add_f32 v30, v30, v62
    v_add_f32 v31, v31, v63
    v_add_f32 v32, v32, v64
    v_add_f32 v33, v33, v65
    v_add_f32 v34, v34, v66
    v_add_f32 v35, v35, v67
    ds_write_b128 v4, v[20:23]
    ds_write_b128 v5, v[24:27]
    ds_write_b128 v6, v[28:31]
    ds_write_b128 v7, v[32:35]
    s_waitcnt lgkmcnt(0)
    s_barrier
END_1:
    s_endpgm
.fill 512, 4, 0xbf810000
.section .rodata,"a"
.p2align 6
.amdhsa_kernel parallel_sum__softmax_full_mha__dense_activation_gelu__prompt_kernel
  .amdhsa_next_free_vgpr 168
  .amdhsa_next_free_sgpr 70
  .amdhsa_accum_offset 168
  .amdhsa_group_segment_fixed_size 0
  .amdhsa_kernarg_size 88
  .amdhsa_user_sgpr_count 2
  .amdhsa_user_sgpr_kernarg_segment_ptr 1
  .amdhsa_system_sgpr_workgroup_id_x 1
.end_amdhsa_kernel
```
